```python
import torch

def _softmax(x, axis=-1):
    return torch.softmax(x, dim=axis)
def _gelu(x):
    return torch.nn.functional.gelu(x, approximate="tanh")
def _silu(x):
    return torch.nn.functional.silu(x)
def _sigmoid(x):
    return torch.sigmoid(x)
def _layernorm(x, axis=-1, eps=1e-5):
    m = x.mean(dim=axis, keepdim=True)
    v = x.var(dim=axis, keepdim=True, unbiased=False)
    return (x - m) / torch.sqrt(v + eps)
def _scatter_add(tgt, idx, src, axis=0):
    return tgt.clone().index_add_(axis, idx, src)
def _segment_sum(src, seg, n):
    out = torch.zeros((n,) + src.shape[1:], dtype=src.dtype)
    return out.index_add_(0, seg, src)
def _pad(x, pw):
    flat = tuple(v for pair in reversed(pw) for v in pair)
    return torch.nn.functional.pad(x, flat)

kernel_name = 'sequential_preLN__linear_attn_block__geglu_ffn__prompt'

def setup_inputs():

    _w = (lambda a: (lambda t: t.to(torch.bfloat16) if t.is_floating_point() else t)(torch.as_tensor(a)))
    def _A_setup():
        B, S, D = 1, 2048, 512
        return {
            "x": _w((lambda *s: torch.randn(*s, dtype=torch.bfloat16) * 0.05)(B, S, D)),
            "wqkv": _w((lambda *s: torch.randn(*s, dtype=torch.bfloat16) * 0.05)(D, 3 * D)),
            "wo": _w((lambda *s: torch.randn(*s, dtype=torch.bfloat16) * 0.05)(D, D)),
        }
    _A_in = _A_setup()

    def _B_setup():
        B, S, D, F = 1, 2048, 512, 1792
        return {
            "x": _w((lambda *s: torch.randn(*s, dtype=torch.bfloat16) * 0.05)(B, S, D)),
            "w_gate": _w((lambda *s: torch.randn(*s, dtype=torch.bfloat16) * 0.05)(D, F)),
            "w_up": _w((lambda *s: torch.randn(*s, dtype=torch.bfloat16) * 0.05)(D, F)),
            "w_down": _w((lambda *s: torch.randn(*s, dtype=torch.bfloat16) * 0.05)(F, D)),
        }
    _B_in = _B_setup()

    return {
        "A_x": _A_in["x"],
        "A_wqkv": _A_in["wqkv"],
        "A_wo": _A_in["wo"],
        "B_x": _B_in["x"],
        "B_w_gate": _B_in["w_gate"],
        "B_w_up": _B_in["w_up"],
        "B_w_down": _B_in["w_down"],
    }

def reference(A_x, A_wqkv, A_wo, B_x, B_w_gate, B_w_up, B_w_down):
    def _A_ref(x, wqkv, wo):
        B, S, D = x.shape
        H = 32; Dh = D // H
        qkv = (lambda x, *d: x.permute(*d))((x @ wqkv).reshape(B, S, 3, H, Dh), 2, 0, 3, 1, 4)
        q, k, v = qkv[0], qkv[1], qkv[2]
        phi = lambda t: torch.where(t > 0, t + 1, torch.exp(t)) + 1e-6
        pq, pk = phi(q), phi(k)
        kv = torch.einsum("bhsd,bhse->bhde", pk, v)
        z = torch.einsum("bhsd->bhd", pk)
        num = torch.einsum("bhqd,bhde->bhqe", pq, kv)
        den = torch.einsum("bhqd,bhd->bhq", pq, z)[..., None] + 1e-6
        o = num / den
        return (lambda x, *d: x.permute(*d))(o, 0, 2, 1, 3).reshape(B, S, D) @ wo

    def _B_ref(x, w_gate, w_up, w_down):
        return (_gelu(x @ w_gate) * (x @ w_up)) @ w_down

    x = A_x
    h = x + _A_ref(_layernorm(x, axis=-1), A_wqkv, A_wo)
    h2 = h + _B_ref(_layernorm(h, axis=-1), B_w_gate, B_w_up, B_w_down)
    return h2
```

```asm
; @launch grid=(256,1,1) block=(256,1,1) lds=163840
.amdgcn_target "amdgcn-amd-amdhsa--gfx950"
.text
.globl sequential_preLN__linear_attn_block__geglu_ffn__prompt_kernel
.p2align 12
s_endpgm
.p2align 8
s_endpgm
.p2align 8
s_endpgm
.p2align 8
s_endpgm
.p2align 8
s_endpgm
.p2align 8
s_endpgm
.p2align 8
s_endpgm
.p2align 8
.type sequential_preLN__linear_attn_block__geglu_ffn__prompt_kernel,@function
sequential_preLN__linear_attn_block__geglu_ffn__prompt_kernel:
    s_cmp_ge_u32 s2, 256
    s_cbranch_scc1 Lend
    s_load_dwordx16 s[16:31], s[0:1], 0
    s_load_dwordx4 s[32:35], s[0:1], 64
    v_lshrrev_b32 v1, 6, v0
    s_lshr_b32 s69, s2, 3
    v_readfirstlane_b32 s3, v1
    v_and_b32 v0, 63, v0
    s_and_b32 s68, s2, 7
    v_lshlrev_b32 v218, 7, v0
    s_xor_b32 s80, s69, 4
    s_cmp_ge_u32 s80, 2
    s_cbranch_scc1 LX_cpf_ret
    s_getpc_b64 s[4:5]
LX_pc:
    s_lshl2_add_u32 s80, s80, s3
    s_lshl_b32 s80, s80, 13
    v_add_u32 v234, s80, v218
    v_min_u32 v234, Lfin-LX_pc-4, v234
    global_load_dword v234, v234, s[4:5]
LX_cpf_ret:
    s_lshr_b32 s76, s68, 1
    s_and_b32 s70, s69, 3
    s_lshl2_add_u32 s70, s76, s70
    s_and_b32 s76, s68, 1
    s_and_b32 s71, s69, 28
    s_lshr_b32 s71, 0x75643120, s71
    s_and_b32 s71, s71, 7
    s_lshl3_add_u32 s71, s76, s71
    s_bfe_u32 s76, s71, 0x20001
    s_lshl2_add_u32 s76, s71, s76
    s_and_b32 s82, s69, 3
    s_add_u32 s82, s82, s76
    s_add_u32 s82, s82, s68
    s_lshl2_add_u32 s72, s70, s3
    s_lshl_b32 s72, s72, 15
    s_mul_i32 s73, s3, 49152
    s_lshl_b32 s76, s71, 6
    s_add_u32 s73, s73, s76
    s_lshl_b32 s74, s3, 14
    s_add_u32 s74, s74, 98304
    s_mul_i32 s75, s3, 3072
    v_lshrrev_b32 v30, 3, v0
    v_and_b32 v31, 7, v0
    v_lshrrev_b32 v32, 1, v30
    v_xor_b32 v31, v31, v32
    v_lshlrev_b32 v31, 4, v31
    v_lshl_add_u32 v4, v30, 10, v31
    v_xor_b32 v5, 64, v4
    v_add_u32 v5, 7168, v5
    v_add_u32 v6, 14336, v4
    v_add_u32 v7, 14336, v5
    v_lshrrev_b32 v30, 2, v0
    v_and_b32 v31, 3, v0
    v_mul_u32_u24 v30, 3072, v30
    v_lshl_add_u32 v8, v31, 4, v30
    s_mov_b32 s38, 2097152
    s_mov_b32 s39, 0x20000
    s_mov_b32 s42, 1572864
    s_mov_b32 s43, 0x20000
    s_add_u32 s78, s82, 0
    s_and_b32 s78, s78, 7
    s_lshl_b32 s76, s78, 7
    s_add_u32 s76, s76, s72
    s_add_u32 m0, s74, 0
    s_mul_i32 s77, s78, 196608
    s_waitcnt lgkmcnt(0)
    s_mov_b64 s[36:37], s[16:17]
    s_mov_b64 s[40:41], s[18:19]
    s_bitcmp1_b32 s69, 3
    s_cbranch_scc1 LS_wf
    buffer_load_dwordx4 v4, s[36:39], s76 offen offset:0 lds
    buffer_load_dwordx4 v5, s[36:39], s76 offen offset:1024 lds
    buffer_load_dwordx4 v6, s[36:39], s76 offen offset:2048 lds
    buffer_load_dwordx4 v7, s[36:39], s76 offen offset:3072 lds
    s_add_u32 m0, s75, 0
    s_add_u32 s77, s77, s73
    buffer_load_dwordx4 v8, s[40:43], s77 offen offset:0 lds
    buffer_load_dwordx4 v8, s[40:43], s77 offen offset:1024 lds
    buffer_load_dwordx4 v8, s[40:43], s77 offen offset:2048 lds
    s_branch LS_j
LS_wf:
    s_add_u32 m0, s75, 0
    s_add_u32 s77, s77, s73
    buffer_load_dwordx4 v8, s[40:43], s77 offen offset:0 lds
    buffer_load_dwordx4 v8, s[40:43], s77 offen offset:1024 lds
    buffer_load_dwordx4 v8, s[40:43], s77 offen offset:2048 lds
    s_mov_b32 m0, s74
    s_nop 0
    buffer_load_dwordx4 v4, s[36:39], s76 offen offset:0 lds
    buffer_load_dwordx4 v5, s[36:39], s76 offen offset:1024 lds
    buffer_load_dwordx4 v6, s[36:39], s76 offen offset:2048 lds
    buffer_load_dwordx4 v7, s[36:39], s76 offen offset:3072 lds
LS_j:
    s_add_u32 s78, s82, 1
    s_and_b32 s78, s78, 7
    s_lshl_b32 s76, s78, 7
    s_add_u32 s76, s76, s72
    s_add_u32 m0, s74, 4096
    s_mul_i32 s77, s78, 196608
    buffer_load_dwordx4 v4, s[36:39], s76 offen offset:0 lds
    buffer_load_dwordx4 v5, s[36:39], s76 offen offset:1024 lds
    buffer_load_dwordx4 v6, s[36:39], s76 offen offset:2048 lds
    buffer_load_dwordx4 v7, s[36:39], s76 offen offset:3072 lds
    s_mov_b64 s[60:61], s[34:35]
    s_mov_b32 s63, 0x20000
    s_and_b32 s81, s69, 3
    s_lshl2_add_u32 s81, s81, s68
    s_lshl2_add_u32 s81, s81, s3
    s_lshl_b32 s80, s81, 10
    s_add_u32 s80, s80, 11796480
    s_xor_b32 s83, s2, 32
    s_and_b32 s83, s83, 0xe4
    s_cselect_b32 s62, 0, 13631488
    v_mov_b32 v24, 0
    v_mov_b32 v25, 0
    v_mov_b32 v26, 0
    v_mov_b32 v27, 0
    v_lshlrev_b32 v1, 4, v0
    buffer_store_dwordx4 v[24:27], v1, s[60:63], s80 offen sc1
    s_mov_b32 s62, 13631488
    s_lshl_b32 s6, s81, 2
    s_mov_b32 s79, s77
    v_lshlrev_b32 v219, 6, v0
    s_lshl2_add_u32 s87, s69, s3
    s_mov_b32 s64, s32
    s_mov_b32 s65, s33
    s_mov_b32 s66, 256
    s_mov_b32 s67, 0x20000
    s_mov_b32 s44, s20
    s_mov_b32 s45, s21
    s_mov_b32 s46, 524288
    s_mov_b32 s47, 0x20000
    s_cmp_ge_u32 s3, 2
    s_cselect_b64 s[48:49], s[26:27], s[24:25]
    s_cmp_ge_u32 s69, 28
    s_cselect_b64 s[48:49], s[28:29], s[48:49]
    s_mov_b32 s50, 1835008
    s_mov_b32 s51, 0x20000
    s_mov_b32 s52, s28
    s_mov_b32 s53, s29
    s_mov_b32 s54, 1835008
    s_mov_b32 s55, 0x20000
    s_mov_b32 s56, s30
    s_mov_b32 s57, s31
    s_mov_b32 s58, 2097152
    s_mov_b32 s59, 0x20000
    v_and_b32 v30, 31, v0
    v_lshrrev_b32 v31, 5, v0
    v_lshrrev_b32 v32, 1, v30
    v_and_b32 v32, 7, v32
    v_xor_b32 v32, v32, v31
    v_lshlrev_b32 v32, 4, v32
    v_lshl_add_u32 v32, v30, 7, v32
    v_add_u32 v32, s74, v32
    s_xor_b32 s76, s3, 0
    s_lshl_b32 s76, s76, 5
    v_xor_b32 v12, s76, v32
    s_xor_b32 s76, s3, 1
    s_lshl_b32 s76, s76, 5
    v_xor_b32 v13, s76, v32
    s_xor_b32 s76, s3, 2
    s_lshl_b32 s76, s76, 5
    v_xor_b32 v14, s76, v32
    s_xor_b32 s76, s3, 3
    s_lshl_b32 s76, s76, 5
    v_xor_b32 v15, s76, v32
    v_bfe_u32 v32, v0, 2, 2
    v_lshl_add_u32 v32, v31, 3, v32
    v_lshlrev_b32 v32, 6, v32
    v_bfe_u32 v33, v0, 4, 1
    v_lshl_add_u32 v32, v33, 5, v32
    v_and_b32 v33, 3, v0
    v_lshl_add_u32 v34, v33, 3, v32
    v_and_b32 v35, 1, v0
    v_lshl_add_u32 v35, v35, 4, v32
    v_bfe_u32 v33, v0, 1, 1
    v_lshl_add_u32 v35, v33, 3, v35
    s_xor_b32 s76, s3, 0
    s_mul_i32 s76, s76, 3072
    v_add_u32 v16, s76, v34
    v_add_u32 v20, s76, v35
    s_xor_b32 s76, s3, 1
    s_mul_i32 s76, s76, 3072
    v_add_u32 v17, s76, v34
    v_add_u32 v21, s76, v35
    s_xor_b32 s76, s3, 2
    s_mul_i32 s76, s76, 3072
    v_add_u32 v18, s76, v34
    v_add_u32 v22, s76, v35
    s_xor_b32 s76, s3, 3
    s_mul_i32 s76, s76, 3072
    v_add_u32 v19, s76, v34
    v_add_u32 v23, s76, v35
    v_mov_b32 v28, 0
    v_mov_b32 v29, 0x3f803f80
    v_lshrrev_b32 v30, 4, v0
    v_and_b32 v31, 15, v0
    v_lshlrev_b32 v32, 1, v30
    v_xor_b32 v31, v31, v32
    v_lshlrev_b32 v31, 4, v31
    v_lshl_add_u32 v220, v30, 10, v31
    v_add_u32 v221, 3072, v220
    v_xor_b32 v222, 128, v220
    v_add_u32 v222, 6144, v222
    v_add_u32 v223, 3072, v222
    v_lshlrev_b32 v217, 2, v0
    s_lshr_b32 s84, s69, 3
    s_lshl_b32 s84, s84, 8
    s_lshl_b32 s76, s3, 17
    s_add_u32 s84, s84, s76
    s_lshl_b32 s85, s3, 12
    v_and_b32 v30, 31, v0
    v_lshl_add_u32 v224, v30, 2, s74
    v_add_u32 v224, 12288, v224
    v_lshlrev_b32 v225, 2, v30
    v_add_u32 v225, 81920, v225
    v_add_u32 v233, 768, v225
    v_lshrrev_b32 v31, 5, v0
    v_lshl_add_u32 v226, v31, 4, s74
    s_mul_i32 s76, s3, 384
    s_add_u32 s76, s76, 81920
    v_lshl_add_u32 v227, v0, 2, s76
    v_add_u32 v229, s74, v0
    v_and_b32 v31, 0x33, v0
    v_bfe_u32 v32, v0, 2, 1
    v_lshl_add_u32 v31, v32, 3, v31
    v_bfe_u32 v32, v0, 3, 1
    v_lshl_add_u32 v31, v32, 2, v31
    v_lshl_add_u32 v228, v31, 4, s74
    s_lshl_b32 s78, s3, 8
    v_lshl_add_u32 v230, v0, 2, s78
    v_add_u32 v231, 111616, v230
    v_min_u32 v232, 111740, v231
    v_mov_b32 v236, v29
    v_mov_b32 v237, v29
    v_mov_b32 v238, v29
    v_mov_b32 v239, v29
    v_mov_b32 v252, -1
    v_mov_b32 v253, v252
    v_mov_b32 v254, v252
    v_mov_b32 v255, v252
    v_lshrrev_b32 v30, 4, v0
    v_xor_b32 v31, v30, v0
    v_and_b32 v31, 3, v31
    v_lshrrev_b32 v32, 2, v0
    v_lshl_add_u32 v31, v32, 6, v31
    v_lshlrev_b32 v248, 4, v31
    v_lshrrev_b32 v31, 1, v0
    v_and_b32 v31, 6, v31
    v_xor_b32 v30, v30, v31
    v_and_b32 v31, 15, v0
    v_lshl_add_u32 v30, v31, 3, v30
    v_lshl_add_u32 v249, v30, 3, s74
    v_xor_b32 v250, 32, v249
    s_lshl_b32 s88, s69, 2
    s_lshr_b32 s88, 0x76325410, s88
    s_and_b32 s88, s88, 7
    s_lshl3_add_u32 s88, s68, s88
    s_lshl_b32 s88, s88, 15
    s_lshr_b32 s89, s69, 3
    s_lshl2_add_u32 s89, s89, s3
    s_lshl_b32 s89, s89, 6
    s_add_u32 s88, s88, s89
    s_add_u32 s89, s88, 16384
    s_mov_b32 s77, s79
    s_add_u32 m0, s75, 12288
    s_add_u32 s77, s77, s73
    buffer_load_dwordx4 v8, s[40:43], s77 offen offset:0 lds
    buffer_load_dwordx4 v8, s[40:43], s77 offen offset:1024 lds
    buffer_load_dwordx4 v8, s[40:43], s77 offen offset:2048 lds
    s_mov_b64 exec, 0
    s_cmp_eq_u32 s3, 0
    s_cbranch_scc1 Lpad_ec00
    s_cmp_eq_u32 s3, 1
    s_cbranch_scc1 Lpad_ec01
    s_cmp_eq_u32 s3, 2
    s_cbranch_scc1 Lpad_ec02
    s_branch Lpad_ec03
Lpad_retc0:
    s_mov_b64 exec, -1
    s_waitcnt vmcnt(8)
    s_barrier
    ds_read_b128 v[88:91], v12 offset:0
    ds_read_b128 v[92:95], v13 offset:0
    ds_read_b128 v[96:99], v14 offset:0
    ds_read_b128 v[100:103], v15 offset:0
Lpad_ec00:
Lpad_1:
    s_cbranch_execz Lpad_retc0
    s_add_u32 s78, s82, 2
    s_and_b32 s78, s78, 7
    s_lshl_b32 s76, s78, 7
    s_add_u32 s76, s76, s72
    s_add_u32 m0, s74, 8192
    s_mul_i32 s77, s78, 196608
    buffer_load_dwordx4 v4, s[36:39], s76 offen offset:0 lds
    ds_read_b64_tr_b16 v[124:125], v16 offset:1024
    ds_read_b64_tr_b16 v[126:127], v16 offset:1280
    ds_read_b64_tr_b16 v[128:129], v16 offset:2048
    ds_read_b64_tr_b16 v[130:131], v16 offset:2304
    buffer_load_dwordx4 v5, s[36:39], s76 offen offset:1024 lds
    ds_read_b64_tr_b16 v[120:121], v20 offset:0
    ds_read_b64_tr_b16 v[122:123], v20 offset:256
    ds_read_b64_tr_b16 v[136:137], v17 offset:1024
    ds_read_b64_tr_b16 v[138:139], v17 offset:1280
    buffer_load_dwordx4 v6, s[36:39], s76 offen offset:2048 lds
    ds_read_b64_tr_b16 v[140:141], v17 offset:2048
    ds_read_b64_tr_b16 v[142:143], v17 offset:2304
    ds_read_b64_tr_b16 v[132:133], v21 offset:0
    ds_read_b64_tr_b16 v[134:135], v21 offset:256
    buffer_load_dwordx4 v7, s[36:39], s76 offen offset:3072 lds
    ds_read_b64_tr_b16 v[148:149], v18 offset:1024
    ds_read_b64_tr_b16 v[150:151], v18 offset:1280
    ds_read_b64_tr_b16 v[152:153], v18 offset:2048
    ds_read_b64_tr_b16 v[154:155], v18 offset:2304
    s_add_u32 m0, s75, 24576
    s_add_u32 s77, s77, s73
    buffer_load_dwordx4 v8, s[40:43], s77 offen offset:0 lds
    ds_read_b64_tr_b16 v[144:145], v22 offset:0
    ds_read_b64_tr_b16 v[146:147], v22 offset:256
    ds_read_b64_tr_b16 v[160:161], v19 offset:1024
    ds_read_b64_tr_b16 v[162:163], v19 offset:1280
    buffer_load_dwordx4 v8, s[40:43], s77 offen offset:1024 lds
    ds_read_b64_tr_b16 v[164:165], v19 offset:2048
    ds_read_b64_tr_b16 v[166:167], v19 offset:2304
    ds_read_b64_tr_b16 v[156:157], v23 offset:0
    ds_read_b64_tr_b16 v[158:159], v23 offset:256
    buffer_load_dwordx4 v8, s[40:43], s77 offen offset:2048 lds
    s_cmp_eq_u32 s83, 0
    s_cselect_b32 s66, 256, 0
    v_mov_b32 v216, 1
    s_mov_b32 s80, 0x35c1a2a0
    s_mov_b32 s86, 0x3f317218
    s_waitcnt lgkmcnt(15)
    v_dot2c_f32_bf16 v26, v120, v29
    v_dot2c_f32_bf16 v27, v124, v29
    v_dot2c_f32_bf16 v28, v128, v29
    v_dot2c_f32_bf16 v26, v121, v29
    v_dot2c_f32_bf16 v27, v125, v29
    v_dot2c_f32_bf16 v28, v129, v29
    v_dot2c_f32_bf16 v26, v122, v29
    v_dot2c_f32_bf16 v27, v126, v29
    v_dot2c_f32_bf16 v28, v130, v29
    v_dot2c_f32_bf16 v26, v123, v29
    v_dot2c_f32_bf16 v27, v127, v29
    v_dot2c_f32_bf16 v28, v131, v29
    v_dot2c_f32_bf16 v24, v88, v29
    v_dot2c_f32_bf16 v25, v88, v88
    v_dot2c_f32_bf16 v24, v89, v29
    v_dot2c_f32_bf16 v25, v89, v89
    v_dot2c_f32_bf16 v24, v90, v29
    v_dot2c_f32_bf16 v25, v90, v90
    v_dot2c_f32_bf16 v24, v91, v29
    v_dot2c_f32_bf16 v25, v91, v91
    v_dot2c_f32_bf16 v24, v92, v29
    v_dot2c_f32_bf16 v25, v92, v92
    v_dot2c_f32_bf16 v24, v93, v29
    v_dot2c_f32_bf16 v25, v93, v93
    v_dot2c_f32_bf16 v24, v94, v29
    v_dot2c_f32_bf16 v25, v94, v94
    v_dot2c_f32_bf16 v24, v95, v29
    v_dot2c_f32_bf16 v25, v95, v95
    v_dot2c_f32_bf16 v24, v96, v29
    v_dot2c_f32_bf16 v25, v96, v96
    v_dot2c_f32_bf16 v24, v97, v29
    v_dot2c_f32_bf16 v25, v97, v97
    v_dot2c_f32_bf16 v24, v98, v29
    v_dot2c_f32_bf16 v25, v98, v98
    v_dot2c_f32_bf16 v24, v99, v29
    v_dot2c_f32_bf16 v25, v99, v99
    v_dot2c_f32_bf16 v24, v100, v29
    v_dot2c_f32_bf16 v25, v100, v100
    v_dot2c_f32_bf16 v24, v101, v29
    v_dot2c_f32_bf16 v25, v101, v101
    v_dot2c_f32_bf16 v24, v102, v29
    v_dot2c_f32_bf16 v25, v102, v102
    v_dot2c_f32_bf16 v24, v103, v29
    v_dot2c_f32_bf16 v25, v103, v103
    s_waitcnt lgkmcnt(0)
    v_mfma_f32_32x32x16_bf16 v[56:71], v[88:91], v[124:127], 0
    s_waitcnt vmcnt(7)
    s_barrier
    s_add_u32 s78, s82, 3
    s_and_b32 s78, s78, 7
    s_lshl_b32 s76, s78, 7
    ds_read_b128 v[104:107], v12 offset:4096
    ds_read_b128 v[108:111], v13 offset:4096
    v_mfma_f32_32x32x16_bf16 v[72:87], v[88:91], v[128:131], 0
    s_add_u32 s76, s76, s72
    s_add_u32 m0, s74, 12288
    s_mul_i32 s77, s78, 196608
    ds_read_b128 v[112:115], v14 offset:4096
    ds_read_b128 v[116:119], v15 offset:4096
    ds_read_b64_tr_b16 v[172:173], v16 offset:13312
    buffer_load_dwordx4 v4, s[36:39], s76 offen offset:0 lds
    v_mfma_f32_32x32x16_bf16 v[40:55], v[120:123], v[88:91], 0
    ds_read_b64_tr_b16 v[174:175], v16 offset:13568
    ds_read_b64_tr_b16 v[176:177], v16 offset:14336
    buffer_store_dword v216, off, s[64:67], s6 sc1
    s_mov_b32 s66, 256
    v_mfma_f32_32x32x16_bf16 v[56:71], v[92:95], v[136:139], v[56:71]
    ds_read_b64_tr_b16 v[178:179], v16 offset:14592
    ds_read_b64_tr_b16 v[168:169], v20 offset:12288
    buffer_load_dwordx4 v5, s[36:39], s76 offen offset:1024 lds
    v_mfma_f32_32x32x16_bf16 v[72:87], v[92:95], v[140:143], v[72:87]
    ds_read_b64_tr_b16 v[170:171], v20 offset:12544
    ds_read_b64_tr_b16 v[184:185], v17 offset:13312
    ds_read_b64_tr_b16 v[186:187], v17 offset:13568
    buffer_load_dwordx4 v6, s[36:39], s76 offen offset:2048 lds
    v_mfma_f32_32x32x16_bf16 v[40:55], v[132:135], v[92:95], v[40:55]
    ds_read_b64_tr_b16 v[188:189], v17 offset:14336
    ds_read_b64_tr_b16 v[190:191], v17 offset:14592
    v_mfma_f32_32x32x16_bf16 v[56:71], v[96:99], v[148:151], v[56:71]
    ds_read_b64_tr_b16 v[180:181], v21 offset:12288
    ds_read_b64_tr_b16 v[182:183], v21 offset:12544
    v_mfma_f32_32x32x16_bf16 v[72:87], v[96:99], v[152:155], v[72:87]
    ds_read_b64_tr_b16 v[196:197], v18 offset:13312
    ds_read_b64_tr_b16 v[198:199], v18 offset:13568
    ds_read_b64_tr_b16 v[200:201], v18 offset:14336
    buffer_load_dwordx4 v7, s[36:39], s76 offen offset:3072 lds
    v_mfma_f32_32x32x16_bf16 v[40:55], v[144:147], v[96:99], v[40:55]
    ds_read_b64_tr_b16 v[202:203], v18 offset:14592
    ds_read_b64_tr_b16 v[192:193], v22 offset:12288
    v_mfma_f32_32x32x16_bf16 v[56:71], v[100:103], v[160:163], v[56:71]
    s_add_u32 m0, s75, 36864
    s_add_u32 s77, s77, s73
    ds_read_b64_tr_b16 v[194:195], v22 offset:12544
    ds_read_b64_tr_b16 v[208:209], v19 offset:13312
    buffer_load_dwordx4 v8, s[40:43], s77 offen offset:0 lds
    v_mfma_f32_32x32x16_bf16 v[72:87], v[100:103], v[164:167], v[72:87]
    ds_read_b64_tr_b16 v[210:211], v19 offset:13568
    ds_read_b64_tr_b16 v[212:213], v19 offset:14336
    ds_read_b64_tr_b16 v[214:215], v19 offset:14592
    v_mfma_f32_32x32x16_bf16 v[40:55], v[156:159], v[100:103], v[40:55]
    ds_read_b64_tr_b16 v[204:205], v23 offset:12288
    ds_read_b64_tr_b16 v[206:207], v23 offset:12544
    s_waitcnt lgkmcnt(15)
    buffer_load_dwordx4 v8, s[40:43], s77 offen offset:1024 lds
    v_dot2c_f32_bf16 v26, v168, v29
    v_dot2c_f32_bf16 v27, v172, v29
    v_dot2c_f32_bf16 v28, v176, v29
    v_dot2c_f32_bf16 v26, v169, v29
    v_dot2c_f32_bf16 v27, v173, v29
    v_dot2c_f32_bf16 v28, v177, v29
    v_dot2c_f32_bf16 v26, v170, v29
    v_dot2c_f32_bf16 v27, v174, v29
    v_dot2c_f32_bf16 v28, v178, v29
    v_dot2c_f32_bf16 v26, v171, v29
    v_dot2c_f32_bf16 v27, v175, v29
    v_dot2c_f32_bf16 v28, v179, v29
    v_dot2c_f32_bf16 v24, v104, v29
    v_dot2c_f32_bf16 v25, v104, v104
    v_dot2c_f32_bf16 v24, v105, v29
    v_dot2c_f32_bf16 v25, v105, v105
    v_dot2c_f32_bf16 v24, v106, v29
    v_dot2c_f32_bf16 v25, v106, v106
    v_dot2c_f32_bf16 v24, v107, v29
    v_dot2c_f32_bf16 v25, v107, v107
    v_dot2c_f32_bf16 v24, v108, v29
    v_dot2c_f32_bf16 v25, v108, v108
    buffer_load_dwordx4 v8, s[40:43], s77 offen offset:2048 lds
    v_dot2c_f32_bf16 v24, v109, v29
    v_dot2c_f32_bf16 v25, v109, v109
    v_dot2c_f32_bf16 v24, v110, v29
    v_dot2c_f32_bf16 v25, v110, v110
    v_dot2c_f32_bf16 v24, v111, v29
    v_dot2c_f32_bf16 v25, v111, v111
    v_dot2c_f32_bf16 v24, v112, v29
    v_dot2c_f32_bf16 v25, v112, v112
    v_dot2c_f32_bf16 v24, v113, v29
    v_dot2c_f32_bf16 v25, v113, v113
    v_dot2c_f32_bf16 v24, v114, v29
    v_dot2c_f32_bf16 v25, v114, v114
    v_dot2c_f32_bf16 v24, v115, v29
    v_dot2c_f32_bf16 v25, v115, v115
    v_dot2c_f32_bf16 v24, v116, v29
    v_dot2c_f32_bf16 v25, v116, v116
    v_dot2c_f32_bf16 v24, v117, v29
    v_dot2c_f32_bf16 v25, v117, v117
    v_dot2c_f32_bf16 v24, v118, v29
    v_dot2c_f32_bf16 v25, v118, v118
    v_dot2c_f32_bf16 v24, v119, v29
    v_dot2c_f32_bf16 v25, v119, v119
    s_waitcnt lgkmcnt(0)
    v_mfma_f32_32x32x16_bf16 v[56:71], v[104:107], v[172:175], v[56:71]
    s_waitcnt vmcnt(8)
    s_barrier
    s_add_u32 s78, s82, 4
    s_and_b32 s78, s78, 7
    s_lshl_b32 s76, s78, 7
    ds_read_b128 v[88:91], v12 offset:8192
    ds_read_b128 v[92:95], v13 offset:8192
    v_mfma_f32_32x32x16_bf16 v[72:87], v[104:107], v[176:179], v[72:87]
    s_add_u32 s76, s76, s72
    s_add_u32 m0, s74, 0
    s_mul_i32 s77, s78, 196608
    ds_read_b128 v[96:99], v14 offset:8192
    ds_read_b128 v[100:103], v15 offset:8192
    ds_read_b64_tr_b16 v[124:125], v16 offset:25600
    buffer_load_dwordx4 v4, s[36:39], s76 offen offset:0 lds
    v_mfma_f32_32x32x16_bf16 v[40:55], v[168:171], v[104:107], v[40:55]
    ds_read_b64_tr_b16 v[126:127], v16 offset:25856
    ds_read_b64_tr_b16 v[128:129], v16 offset:26624
    buffer_load_dwordx4 v5, s[36:39], s76 offen offset:1024 lds
    v_mfma_f32_32x32x16_bf16 v[56:71], v[108:111], v[184:187], v[56:71]
    ds_read_b64_tr_b16 v[130:131], v16 offset:26880
    ds_read_b64_tr_b16 v[120:121], v20 offset:24576
    v_mfma_f32_32x32x16_bf16 v[72:87], v[108:111], v[188:191], v[72:87]
    ds_read_b64_tr_b16 v[122:123], v20 offset:24832
    ds_read_b64_tr_b16 v[136:137], v17 offset:25600
    ds_read_b64_tr_b16 v[138:139], v17 offset:25856
    buffer_load_dwordx4 v6, s[36:39], s76 offen offset:2048 lds
    v_mfma_f32_32x32x16_bf16 v[40:55], v[180:183], v[108:111], v[40:55]
    ds_read_b64_tr_b16 v[140:141], v17 offset:26624
    ds_read_b64_tr_b16 v[142:143], v17 offset:26880
    v_mfma_f32_32x32x16_bf16 v[56:71], v[112:115], v[196:199], v[56:71]
    ds_read_b64_tr_b16 v[132:133], v21 offset:24576
    ds_read_b64_tr_b16 v[134:135], v21 offset:24832
    v_mfma_f32_32x32x16_bf16 v[72:87], v[112:115], v[200:203], v[72:87]
    ds_read_b64_tr_b16 v[148:149], v18 offset:25600
    ds_read_b64_tr_b16 v[150:151], v18 offset:25856
    ds_read_b64_tr_b16 v[152:153], v18 offset:26624
    buffer_load_dwordx4 v7, s[36:39], s76 offen offset:3072 lds
    v_mfma_f32_32x32x16_bf16 v[40:55], v[192:195], v[112:115], v[40:55]
    ds_read_b64_tr_b16 v[154:155], v18 offset:26880
    ds_read_b64_tr_b16 v[144:145], v22 offset:24576
    v_mfma_f32_32x32x16_bf16 v[56:71], v[116:119], v[208:211], v[56:71]
    s_add_u32 m0, s75, 49152
    s_add_u32 s77, s77, s73
    ds_read_b64_tr_b16 v[146:147], v22 offset:24832
    ds_read_b64_tr_b16 v[160:161], v19 offset:25600
    buffer_load_dwordx4 v8, s[40:43], s77 offen offset:0 lds
    v_mfma_f32_32x32x16_bf16 v[72:87], v[116:119], v[212:215], v[72:87]
    ds_read_b64_tr_b16 v[162:163], v19 offset:25856
    ds_read_b64_tr_b16 v[164:165], v19 offset:26624
    ds_read_b64_tr_b16 v[166:167], v19 offset:26880
    v_mfma_f32_32x32x16_bf16 v[40:55], v[204:207], v[116:119], v[40:55]
    ds_read_b64_tr_b16 v[156:157], v23 offset:24576
    ds_read_b64_tr_b16 v[158:159], v23 offset:24832
    s_waitcnt lgkmcnt(15)
    buffer_load_dwordx4 v8, s[40:43], s77 offen offset:1024 lds
    v_dot2c_f32_bf16 v26, v120, v29
    v_dot2c_f32_bf16 v27, v124, v29
    v_dot2c_f32_bf16 v28, v128, v29
    v_dot2c_f32_bf16 v26, v121, v29
    v_dot2c_f32_bf16 v27, v125, v29
    v_dot2c_f32_bf16 v28, v129, v29
    v_dot2c_f32_bf16 v26, v122, v29
    v_dot2c_f32_bf16 v27, v126, v29
    v_dot2c_f32_bf16 v28, v130, v29
    v_dot2c_f32_bf16 v26, v123, v29
    v_dot2c_f32_bf16 v27, v127, v29
    v_dot2c_f32_bf16 v28, v131, v29
    v_dot2c_f32_bf16 v24, v88, v29
    v_dot2c_f32_bf16 v25, v88, v88
    v_dot2c_f32_bf16 v24, v89, v29
    v_dot2c_f32_bf16 v25, v89, v89
    v_dot2c_f32_bf16 v24, v90, v29
    v_dot2c_f32_bf16 v25, v90, v90
    v_dot2c_f32_bf16 v24, v91, v29
    v_dot2c_f32_bf16 v25, v91, v91
    v_dot2c_f32_bf16 v24, v92, v29
    v_dot2c_f32_bf16 v25, v92, v92
    buffer_load_dwordx4 v8, s[40:43], s77 offen offset:2048 lds
    v_dot2c_f32_bf16 v24, v93, v29
    v_dot2c_f32_bf16 v25, v93, v93
    v_dot2c_f32_bf16 v24, v94, v29
    v_dot2c_f32_bf16 v25, v94, v94
    v_dot2c_f32_bf16 v24, v95, v29
    v_dot2c_f32_bf16 v25, v95, v95
    v_dot2c_f32_bf16 v24, v96, v29
    v_dot2c_f32_bf16 v25, v96, v96
    v_dot2c_f32_bf16 v24, v97, v29
    v_dot2c_f32_bf16 v25, v97, v97
    v_dot2c_f32_bf16 v24, v98, v29
    v_dot2c_f32_bf16 v25, v98, v98
    v_dot2c_f32_bf16 v24, v99, v29
    v_dot2c_f32_bf16 v25, v99, v99
    v_dot2c_f32_bf16 v24, v100, v29
    v_dot2c_f32_bf16 v25, v100, v100
    v_dot2c_f32_bf16 v24, v101, v29
    v_dot2c_f32_bf16 v25, v101, v101
    v_dot2c_f32_bf16 v24, v102, v29
    v_dot2c_f32_bf16 v25, v102, v102
    v_dot2c_f32_bf16 v24, v103, v29
    v_dot2c_f32_bf16 v25, v103, v103
    s_waitcnt lgkmcnt(0)
    v_mfma_f32_32x32x16_bf16 v[56:71], v[88:91], v[124:127], v[56:71]
    s_waitcnt vmcnt(7)
    s_barrier
    s_add_u32 s78, s82, 5
    s_and_b32 s78, s78, 7
    s_lshl_b32 s76, s78, 7
    ds_read_b128 v[104:107], v12 offset:12288
    ds_read_b128 v[108:111], v13 offset:12288
    v_mfma_f32_32x32x16_bf16 v[72:87], v[88:91], v[128:131], v[72:87]
    s_add_u32 s76, s76, s72
    s_add_u32 m0, s74, 4096
    s_mul_i32 s77, s78, 196608
    ds_read_b128 v[112:115], v14 offset:12288
    ds_read_b128 v[116:119], v15 offset:12288
    ds_read_b64_tr_b16 v[172:173], v16 offset:37888
    buffer_load_dwordx4 v4, s[36:39], s76 offen offset:0 lds
    v_mfma_f32_32x32x16_bf16 v[40:55], v[120:123], v[88:91], v[40:55]
    ds_read_b64_tr_b16 v[174:175], v16 offset:38144
    ds_read_b64_tr_b16 v[176:177], v16 offset:38912
    buffer_load_dwordx4 v5, s[36:39], s76 offen offset:1024 lds
    v_mfma_f32_32x32x16_bf16 v[56:71], v[92:95], v[136:139], v[56:71]
    ds_read_b64_tr_b16 v[178:179], v16 offset:39168
    ds_read_b64_tr_b16 v[168:169], v20 offset:36864
    v_mfma_f32_32x32x16_bf16 v[72:87], v[92:95], v[140:143], v[72:87]
    ds_read_b64_tr_b16 v[170:171], v20 offset:37120
    ds_read_b64_tr_b16 v[184:185], v17 offset:37888
    ds_read_b64_tr_b16 v[186:187], v17 offset:38144
    buffer_load_dwordx4 v6, s[36:39], s76 offen offset:2048 lds
    v_mfma_f32_32x32x16_bf16 v[40:55], v[132:135], v[92:95], v[40:55]
    ds_read_b64_tr_b16 v[188:189], v17 offset:38912
    ds_read_b64_tr_b16 v[190:191], v17 offset:39168
    v_mfma_f32_32x32x16_bf16 v[56:71], v[96:99], v[148:151], v[56:71]
    ds_read_b64_tr_b16 v[180:181], v21 offset:36864
    ds_read_b64_tr_b16 v[182:183], v21 offset:37120
    v_mfma_f32_32x32x16_bf16 v[72:87], v[96:99], v[152:155], v[72:87]
    ds_read_b64_tr_b16 v[196:197], v18 offset:37888
    ds_read_b64_tr_b16 v[198:199], v18 offset:38144
    ds_read_b64_tr_b16 v[200:201], v18 offset:38912
    buffer_load_dwordx4 v7, s[36:39], s76 offen offset:3072 lds
    v_mfma_f32_32x32x16_bf16 v[40:55], v[144:147], v[96:99], v[40:55]
    ds_read_b64_tr_b16 v[202:203], v18 offset:39168
    ds_read_b64_tr_b16 v[192:193], v22 offset:36864
    v_mfma_f32_32x32x16_bf16 v[56:71], v[100:103], v[160:163], v[56:71]
    s_add_u32 m0, s75, 61440
    s_add_u32 s77, s77, s73
    ds_read_b64_tr_b16 v[194:195], v22 offset:37120
    ds_read_b64_tr_b16 v[208:209], v19 offset:37888
    buffer_load_dwordx4 v8, s[40:43], s77 offen offset:0 lds
    v_mfma_f32_32x32x16_bf16 v[72:87], v[100:103], v[164:167], v[72:87]
    ds_read_b64_tr_b16 v[210:211], v19 offset:38144
    ds_read_b64_tr_b16 v[212:213], v19 offset:38912
    ds_read_b64_tr_b16 v[214:215], v19 offset:39168
    v_mfma_f32_32x32x16_bf16 v[40:55], v[156:159], v[100:103], v[40:55]
    ds_read_b64_tr_b16 v[204:205], v23 offset:36864
    ds_read_b64_tr_b16 v[206:207], v23 offset:37120
    s_waitcnt lgkmcnt(15)
    v_add_u32 v16, 49152, v16
    v_add_u32 v20, 49152, v20
    v_add_u32 v17, 49152, v17
    v_add_u32 v21, 49152, v21
    v_add_u32 v18, 49152, v18
    v_add_u32 v22, 49152, v22
    v_add_u32 v19, 49152, v19
    v_add_u32 v23, 49152, v23
    buffer_load_dwordx4 v8, s[40:43], s77 offen offset:1024 lds
    v_dot2c_f32_bf16 v26, v168, v29
    v_dot2c_f32_bf16 v27, v172, v29
    v_dot2c_f32_bf16 v28, v176, v29
    v_dot2c_f32_bf16 v26, v169, v29
    v_dot2c_f32_bf16 v27, v173, v29
    v_dot2c_f32_bf16 v28, v177, v29
    v_dot2c_f32_bf16 v26, v170, v29
    v_dot2c_f32_bf16 v27, v174, v29
    v_dot2c_f32_bf16 v28, v178, v29
    v_dot2c_f32_bf16 v26, v171, v29
    v_dot2c_f32_bf16 v27, v175, v29
    v_dot2c_f32_bf16 v28, v179, v29
    v_dot2c_f32_bf16 v24, v104, v29
    v_dot2c_f32_bf16 v25, v104, v104
    v_dot2c_f32_bf16 v24, v105, v29
    v_dot2c_f32_bf16 v25, v105, v105
    v_dot2c_f32_bf16 v24, v106, v29
    v_dot2c_f32_bf16 v25, v106, v106
    v_dot2c_f32_bf16 v24, v107, v29
    v_dot2c_f32_bf16 v25, v107, v107
    v_dot2c_f32_bf16 v24, v108, v29
    v_dot2c_f32_bf16 v25, v108, v108
    buffer_load_dwordx4 v8, s[40:43], s77 offen offset:2048 lds
    v_dot2c_f32_bf16 v24, v109, v29
    v_dot2c_f32_bf16 v25, v109, v109
    v_dot2c_f32_bf16 v24, v110, v29
    v_dot2c_f32_bf16 v25, v110, v110
    v_dot2c_f32_bf16 v24, v111, v29
    v_dot2c_f32_bf16 v25, v111, v111
    v_dot2c_f32_bf16 v24, v112, v29
    v_dot2c_f32_bf16 v25, v112, v112
    v_dot2c_f32_bf16 v24, v113, v29
    v_dot2c_f32_bf16 v25, v113, v113
    v_dot2c_f32_bf16 v24, v114, v29
    v_dot2c_f32_bf16 v25, v114, v114
    v_dot2c_f32_bf16 v24, v115, v29
    v_dot2c_f32_bf16 v25, v115, v115
    v_dot2c_f32_bf16 v24, v116, v29
    v_dot2c_f32_bf16 v25, v116, v116
    v_dot2c_f32_bf16 v24, v117, v29
    v_dot2c_f32_bf16 v25, v117, v117
    v_dot2c_f32_bf16 v24, v118, v29
    v_dot2c_f32_bf16 v25, v118, v118
    v_dot2c_f32_bf16 v24, v119, v29
    v_dot2c_f32_bf16 v25, v119, v119
    s_waitcnt lgkmcnt(0)
    v_mfma_f32_32x32x16_bf16 v[56:71], v[104:107], v[172:175], v[56:71]
    s_waitcnt vmcnt(7)
    s_barrier
    s_add_u32 s78, s82, 6
    s_and_b32 s78, s78, 7
    s_lshl_b32 s76, s78, 7
    ds_read_b128 v[88:91], v12 offset:0
    ds_read_b128 v[92:95], v13 offset:0
    v_mfma_f32_32x32x16_bf16 v[72:87], v[104:107], v[176:179], v[72:87]
    s_add_u32 s76, s76, s72
    s_add_u32 m0, s74, 8192
    s_mul_i32 s77, s78, 196608
    ds_read_b128 v[96:99], v14 offset:0
    ds_read_b128 v[100:103], v15 offset:0
    ds_read_b64_tr_b16 v[124:125], v16 offset:1024
    buffer_load_dwordx4 v4, s[36:39], s76 offen offset:0 lds
    v_mfma_f32_32x32x16_bf16 v[40:55], v[168:171], v[104:107], v[40:55]
    ds_read_b64_tr_b16 v[126:127], v16 offset:1280
    ds_read_b64_tr_b16 v[128:129], v16 offset:2048
    buffer_load_dwordx4 v5, s[36:39], s76 offen offset:1024 lds
    v_mfma_f32_32x32x16_bf16 v[56:71], v[108:111], v[184:187], v[56:71]
    ds_read_b64_tr_b16 v[130:131], v16 offset:2304
    ds_read_b64_tr_b16 v[120:121], v20 offset:0
    v_mfma_f32_32x32x16_bf16 v[72:87], v[108:111], v[188:191], v[72:87]
    ds_read_b64_tr_b16 v[122:123], v20 offset:256
    ds_read_b64_tr_b16 v[136:137], v17 offset:1024
    ds_read_b64_tr_b16 v[138:139], v17 offset:1280
    buffer_load_dwordx4 v6, s[36:39], s76 offen offset:2048 lds
    v_mfma_f32_32x32x16_bf16 v[40:55], v[180:183], v[108:111], v[40:55]
    ds_read_b64_tr_b16 v[140:141], v17 offset:2048
    ds_read_b64_tr_b16 v[142:143], v17 offset:2304
    v_mfma_f32_32x32x16_bf16 v[56:71], v[112:115], v[196:199], v[56:71]
    ds_read_b64_tr_b16 v[132:133], v21 offset:0
    ds_read_b64_tr_b16 v[134:135], v21 offset:256
    v_mfma_f32_32x32x16_bf16 v[72:87], v[112:115], v[200:203], v[72:87]
    ds_read_b64_tr_b16 v[148:149], v18 offset:1024
    ds_read_b64_tr_b16 v[150:151], v18 offset:1280
    ds_read_b64_tr_b16 v[152:153], v18 offset:2048
    buffer_load_dwordx4 v7, s[36:39], s76 offen offset:3072 lds
    v_mfma_f32_32x32x16_bf16 v[40:55], v[192:195], v[112:115], v[40:55]
    ds_read_b64_tr_b16 v[154:155], v18 offset:2304
    ds_read_b64_tr_b16 v[144:145], v22 offset:0
    v_mfma_f32_32x32x16_bf16 v[56:71], v[116:119], v[208:211], v[56:71]
    s_add_u32 m0, s75, 73728
    s_add_u32 s77, s77, s73
    ds_read_b64_tr_b16 v[146:147], v22 offset:256
    ds_read_b64_tr_b16 v[160:161], v19 offset:1024
    buffer_load_dwordx4 v8, s[40:43], s77 offen offset:0 lds
    v_mfma_f32_32x32x16_bf16 v[72:87], v[116:119], v[212:215], v[72:87]
    ds_read_b64_tr_b16 v[162:163], v19 offset:1280
    ds_read_b64_tr_b16 v[164:165], v19 offset:2048
    ds_read_b64_tr_b16 v[166:167], v19 offset:2304
    v_mfma_f32_32x32x16_bf16 v[40:55], v[204:207], v[116:119], v[40:55]
    ds_read_b64_tr_b16 v[156:157], v23 offset:0
    ds_read_b64_tr_b16 v[158:159], v23 offset:256
    s_waitcnt lgkmcnt(15)
    buffer_load_dwordx4 v8, s[40:43], s77 offen offset:1024 lds
    v_dot2c_f32_bf16 v26, v120, v29
    v_dot2c_f32_bf16 v27, v124, v29
    v_dot2c_f32_bf16 v28, v128, v29
    v_dot2c_f32_bf16 v26, v121, v29
    v_dot2c_f32_bf16 v27, v125, v29
    v_dot2c_f32_bf16 v28, v129, v29
    v_dot2c_f32_bf16 v26, v122, v29
    v_dot2c_f32_bf16 v27, v126, v29
    v_dot2c_f32_bf16 v28, v130, v29
    v_dot2c_f32_bf16 v26, v123, v29
    v_dot2c_f32_bf16 v27, v127, v29
    v_dot2c_f32_bf16 v28, v131, v29
    v_dot2c_f32_bf16 v24, v88, v29
    v_dot2c_f32_bf16 v25, v88, v88
    v_dot2c_f32_bf16 v24, v89, v29
    v_dot2c_f32_bf16 v25, v89, v89
    v_dot2c_f32_bf16 v24, v90, v29
    v_dot2c_f32_bf16 v25, v90, v90
    v_dot2c_f32_bf16 v24, v91, v29
    v_dot2c_f32_bf16 v25, v91, v91
    v_dot2c_f32_bf16 v24, v92, v29
    v_dot2c_f32_bf16 v25, v92, v92
    buffer_load_dwordx4 v8, s[40:43], s77 offen offset:2048 lds
    v_dot2c_f32_bf16 v24, v93, v29
    v_dot2c_f32_bf16 v25, v93, v93
    v_dot2c_f32_bf16 v24, v94, v29
    v_dot2c_f32_bf16 v25, v94, v94
    v_dot2c_f32_bf16 v24, v95, v29
    v_dot2c_f32_bf16 v25, v95, v95
    v_dot2c_f32_bf16 v24, v96, v29
    v_dot2c_f32_bf16 v25, v96, v96
    v_dot2c_f32_bf16 v24, v97, v29
    v_dot2c_f32_bf16 v25, v97, v97
    v_dot2c_f32_bf16 v24, v98, v29
    v_dot2c_f32_bf16 v25, v98, v98
    v_dot2c_f32_bf16 v24, v99, v29
    v_dot2c_f32_bf16 v25, v99, v99
    v_dot2c_f32_bf16 v24, v100, v29
    v_dot2c_f32_bf16 v25, v100, v100
    v_dot2c_f32_bf16 v24, v101, v29
    v_dot2c_f32_bf16 v25, v101, v101
    v_dot2c_f32_bf16 v24, v102, v29
    v_dot2c_f32_bf16 v25, v102, v102
    v_dot2c_f32_bf16 v24, v103, v29
    v_dot2c_f32_bf16 v25, v103, v103
    s_waitcnt lgkmcnt(0)
    v_mfma_f32_32x32x16_bf16 v[56:71], v[88:91], v[124:127], v[56:71]
    s_waitcnt vmcnt(7)
    s_barrier
    s_add_u32 s78, s82, 7
    s_and_b32 s78, s78, 7
    s_lshl_b32 s76, s78, 7
    ds_read_b128 v[104:107], v12 offset:4096
    ds_read_b128 v[108:111], v13 offset:4096
    v_mfma_f32_32x32x16_bf16 v[72:87], v[88:91], v[128:131], v[72:87]
    s_add_u32 s76, s76, s72
    s_add_u32 m0, s74, 12288
    s_mul_i32 s77, s78, 196608
    ds_read_b128 v[112:115], v14 offset:4096
    ds_read_b128 v[116:119], v15 offset:4096
    ds_read_b64_tr_b16 v[172:173], v16 offset:13312
    buffer_load_dwordx4 v4, s[36:39], s76 offen offset:0 lds
    v_mfma_f32_32x32x16_bf16 v[40:55], v[120:123], v[88:91], v[40:55]
    ds_read_b64_tr_b16 v[174:175], v16 offset:13568
    ds_read_b64_tr_b16 v[176:177], v16 offset:14336
    buffer_load_dwordx4 v5, s[36:39], s76 offen offset:1024 lds
    v_mfma_f32_32x32x16_bf16 v[56:71], v[92:95], v[136:139], v[56:71]
    ds_read_b64_tr_b16 v[178:179], v16 offset:14592
    ds_read_b64_tr_b16 v[168:169], v20 offset:12288
    buffer_load_dwordx4 v6, s[36:39], s76 offen offset:2048 lds
    v_mfma_f32_32x32x16_bf16 v[72:87], v[92:95], v[140:143], v[72:87]
    ds_read_b64_tr_b16 v[170:171], v20 offset:12544
    ds_read_b64_tr_b16 v[184:185], v17 offset:13312
    ds_read_b64_tr_b16 v[186:187], v17 offset:13568
    v_mfma_f32_32x32x16_bf16 v[40:55], v[132:135], v[92:95], v[40:55]
    ds_read_b64_tr_b16 v[188:189], v17 offset:14336
    ds_read_b64_tr_b16 v[190:191], v17 offset:14592
    buffer_load_dwordx4 v7, s[36:39], s76 offen offset:3072 lds
    v_mfma_f32_32x32x16_bf16 v[56:71], v[96:99], v[148:151], v[56:71]
    s_add_u32 m0, s75, 86016
    s_add_u32 s77, s77, s73
    ds_read_b64_tr_b16 v[180:181], v21 offset:12288
    ds_read_b64_tr_b16 v[182:183], v21 offset:12544
    buffer_load_dwordx4 v8, s[40:43], s77 offen offset:0 lds
    v_mfma_f32_32x32x16_bf16 v[72:87], v[96:99], v[152:155], v[72:87]
    ds_read_b64_tr_b16 v[196:197], v18 offset:13312
    ds_read_b64_tr_b16 v[198:199], v18 offset:13568
    ds_read_b64_tr_b16 v[200:201], v18 offset:14336
    v_mfma_f32_32x32x16_bf16 v[40:55], v[144:147], v[96:99], v[40:55]
    ds_read_b64_tr_b16 v[202:203], v18 offset:14592
    ds_read_b64_tr_b16 v[192:193], v22 offset:12288
    buffer_load_dwordx4 v8, s[40:43], s77 offen offset:1024 lds
    v_mfma_f32_32x32x16_bf16 v[56:71], v[100:103], v[160:163], v[56:71]
    ds_read_b64_tr_b16 v[194:195], v22 offset:12544
    ds_read_b64_tr_b16 v[208:209], v19 offset:13312
    v_mfma_f32_32x32x16_bf16 v[72:87], v[100:103], v[164:167], v[72:87]
    ds_read_b64_tr_b16 v[210:211], v19 offset:13568
    ds_read_b64_tr_b16 v[212:213], v19 offset:14336
    ds_read_b64_tr_b16 v[214:215], v19 offset:14592
    buffer_load_dwordx4 v8, s[40:43], s77 offen offset:2048 lds
    v_mfma_f32_32x32x16_bf16 v[40:55], v[156:159], v[100:103], v[40:55]
    ds_read_b64_tr_b16 v[204:205], v23 offset:12288
    ds_read_b64_tr_b16 v[206:207], v23 offset:12544
    s_waitcnt lgkmcnt(15)
    s_add_u32 m0, s74, 0
    s_nop 0
    buffer_load_dwordx4 v248, s[36:39], s88 offen lds
    v_dot2c_f32_bf16 v26, v168, v29
    v_dot2c_f32_bf16 v27, v172, v29
    v_dot2c_f32_bf16 v28, v176, v29
    v_dot2c_f32_bf16 v26, v169, v29
    v_dot2c_f32_bf16 v27, v173, v29
    v_dot2c_f32_bf16 v28, v177, v29
    v_dot2c_f32_bf16 v26, v170, v29
    v_dot2c_f32_bf16 v27, v174, v29
    v_dot2c_f32_bf16 v28, v178, v29
    v_dot2c_f32_bf16 v26, v171, v29
    v_dot2c_f32_bf16 v27, v175, v29
    v_dot2c_f32_bf16 v28, v179, v29
    v_dot2c_f32_bf16 v24, v104, v29
    v_dot2c_f32_bf16 v25, v104, v104
    v_dot2c_f32_bf16 v24, v105, v29
    s_add_u32 m0, s74, 1024
    s_nop 0
    buffer_load_dwordx4 v248, s[36:39], s89 offen lds
    v_dot2c_f32_bf16 v25, v105, v105
    v_dot2c_f32_bf16 v24, v106, v29
    v_dot2c_f32_bf16 v25, v106, v106
    v_dot2c_f32_bf16 v24, v107, v29
    v_dot2c_f32_bf16 v25, v107, v107
    v_dot2c_f32_bf16 v24, v108, v29
    v_dot2c_f32_bf16 v25, v108, v108
    v_dot2c_f32_bf16 v24, v109, v29
    v_dot2c_f32_bf16 v25, v109, v109
    v_dot2c_f32_bf16 v24, v110, v29
    v_dot2c_f32_bf16 v25, v110, v110
    v_dot2c_f32_bf16 v24, v111, v29
    v_dot2c_f32_bf16 v25, v111, v111
    v_dot2c_f32_bf16 v24, v112, v29
    v_dot2c_f32_bf16 v25, v112, v112
    buffer_load_dword v216, v217, s[64:67], 0 offen sc1
    v_dot2c_f32_bf16 v24, v113, v29
    v_dot2c_f32_bf16 v25, v113, v113
    v_dot2c_f32_bf16 v24, v114, v29
    v_dot2c_f32_bf16 v25, v114, v114
    v_dot2c_f32_bf16 v24, v115, v29
    v_dot2c_f32_bf16 v25, v115, v115
    v_dot2c_f32_bf16 v24, v116, v29
    v_dot2c_f32_bf16 v25, v116, v116
    v_dot2c_f32_bf16 v24, v117, v29
    v_dot2c_f32_bf16 v25, v117, v117
    v_dot2c_f32_bf16 v24, v118, v29
    v_dot2c_f32_bf16 v25, v118, v118
    v_dot2c_f32_bf16 v24, v119, v29
    v_dot2c_f32_bf16 v25, v119, v119
    s_waitcnt lgkmcnt(0)
    v_mfma_f32_32x32x16_bf16 v[56:71], v[104:107], v[172:175], v[56:71]
    s_waitcnt vmcnt(10)
    s_barrier
    s_lshl_b32 s81, s87, 12
    buffer_load_dword v235, v219, s[44:47], s81 offen
    ds_read_b128 v[88:91], v12 offset:8192
    ds_read_b128 v[92:95], v13 offset:8192
    v_mfma_f32_32x32x16_bf16 v[72:87], v[104:107], v[176:179], v[72:87]
    ds_read_b128 v[96:99], v14 offset:8192
    ds_read_b128 v[100:103], v15 offset:8192
    ds_read_b64_tr_b16 v[124:125], v16 offset:25600
    v_mfma_f32_32x32x16_bf16 v[40:55], v[168:171], v[104:107], v[40:55]
    ds_read_b64_tr_b16 v[126:127], v16 offset:25856
    ds_read_b64_tr_b16 v[128:129], v16 offset:26624
    v_mfma_f32_32x32x16_bf16 v[56:71], v[108:111], v[184:187], v[56:71]
    ds_read_b64_tr_b16 v[130:131], v16 offset:26880
    ds_read_b64_tr_b16 v[120:121], v20 offset:24576
    v_mfma_f32_32x32x16_bf16 v[72:87], v[108:111], v[188:191], v[72:87]
    ds_read_b64_tr_b16 v[122:123], v20 offset:24832
    ds_read_b64_tr_b16 v[136:137], v17 offset:25600
    ds_read_b64_tr_b16 v[138:139], v17 offset:25856
    v_mfma_f32_32x32x16_bf16 v[40:55], v[180:183], v[108:111], v[40:55]
    ds_read_b64_tr_b16 v[140:141], v17 offset:26624
    ds_read_b64_tr_b16 v[142:143], v17 offset:26880
    v_mfma_f32_32x32x16_bf16 v[56:71], v[112:115], v[196:199], v[56:71]
    s_bitcmp1_b32 s3, 0
    s_cselect_b64 s[4:5], s[26:27], s[24:25]
    s_mov_b32 s6, 1835008
    s_mov_b32 s7, 0x20000
    s_lshr_b32 s81, s87, 1
    s_lshl3_add_u32 s81, s81, s68
    s_mul_i32 s81, s81, 3584
    v_min_u32 v234, 3456, v218
    buffer_load_dword v235, v234, s[4:7], s81 offen
    ds_read_b64_tr_b16 v[132:133], v21 offset:24576
    ds_read_b64_tr_b16 v[134:135], v21 offset:24832
    v_mfma_f32_32x32x16_bf16 v[72:87], v[112:115], v[200:203], v[72:87]
    ds_read_b64_tr_b16 v[148:149], v18 offset:25600
    ds_read_b64_tr_b16 v[150:151], v18 offset:25856
    ds_read_b64_tr_b16 v[152:153], v18 offset:26624
    v_mfma_f32_32x32x16_bf16 v[40:55], v[192:195], v[112:115], v[40:55]
    ds_read_b64_tr_b16 v[154:155], v18 offset:26880
    ds_read_b64_tr_b16 v[144:145], v22 offset:24576
    v_mfma_f32_32x32x16_bf16 v[56:71], v[116:119], v[208:211], v[56:71]
    ds_read_b64_tr_b16 v[146:147], v22 offset:24832
    ds_read_b64_tr_b16 v[160:161], v19 offset:25600
    v_mfma_f32_32x32x16_bf16 v[72:87], v[116:119], v[212:215], v[72:87]
    ds_read_b64_tr_b16 v[162:163], v19 offset:25856
    ds_read_b64_tr_b16 v[164:165], v19 offset:26624
    ds_read_b64_tr_b16 v[166:167], v19 offset:26880
    v_mfma_f32_32x32x16_bf16 v[40:55], v[204:207], v[116:119], v[40:55]
    ds_read_b64_tr_b16 v[156:157], v23 offset:24576
    ds_read_b64_tr_b16 v[158:159], v23 offset:24832
Lpad_ec01:
Lpad_2:
    s_cbranch_execz Lpad_retc0
    s_waitcnt lgkmcnt(15)
    s_lshl3_add_u32 s81, s87, s68
    s_mul_i32 s81, s81, 1792
    v_min_u32 v234, 1664, v218
    buffer_load_dword v235, v234, s[52:55], s81 offen
    v_dot2c_f32_bf16 v26, v120, v29
    v_dot2c_f32_bf16 v27, v124, v29
    v_dot2c_f32_bf16 v28, v128, v29
    v_dot2c_f32_bf16 v26, v121, v29
    v_dot2c_f32_bf16 v27, v125, v29
    v_dot2c_f32_bf16 v28, v129, v29
    v_dot2c_f32_bf16 v26, v122, v29
    v_dot2c_f32_bf16 v27, v126, v29
    v_dot2c_f32_bf16 v28, v130, v29
    v_dot2c_f32_bf16 v26, v123, v29
    v_dot2c_f32_bf16 v27, v127, v29
    v_dot2c_f32_bf16 v28, v131, v29
    v_dot2c_f32_bf16 v24, v88, v29
    v_dot2c_f32_bf16 v25, v88, v88
    v_dot2c_f32_bf16 v24, v89, v29
    v_dot2c_f32_bf16 v25, v89, v89
    v_dot2c_f32_bf16 v24, v90, v29
    v_dot2c_f32_bf16 v25, v90, v90
    v_dot2c_f32_bf16 v24, v91, v29
    v_dot2c_f32_bf16 v25, v91, v91
    v_dot2c_f32_bf16 v24, v92, v29
    v_dot2c_f32_bf16 v25, v92, v92
    v_dot2c_f32_bf16 v24, v93, v29
    v_dot2c_f32_bf16 v25, v93, v93
    v_dot2c_f32_bf16 v24, v94, v29
    v_dot2c_f32_bf16 v25, v94, v94
    v_dot2c_f32_bf16 v24, v95, v29
    v_dot2c_f32_bf16 v25, v95, v95
    v_dot2c_f32_bf16 v24, v96, v29
    v_dot2c_f32_bf16 v25, v96, v96
    v_dot2c_f32_bf16 v24, v97, v29
    v_dot2c_f32_bf16 v25, v97, v97
    v_dot2c_f32_bf16 v24, v98, v29
    v_dot2c_f32_bf16 v25, v98, v98
    v_dot2c_f32_bf16 v24, v99, v29
    v_dot2c_f32_bf16 v25, v99, v99
    v_dot2c_f32_bf16 v24, v100, v29
    v_dot2c_f32_bf16 v25, v100, v100
    v_dot2c_f32_bf16 v24, v101, v29
    v_dot2c_f32_bf16 v25, v101, v101
    v_dot2c_f32_bf16 v24, v102, v29
    v_dot2c_f32_bf16 v25, v102, v102
    v_dot2c_f32_bf16 v24, v103, v29
    v_dot2c_f32_bf16 v25, v103, v103
    s_waitcnt lgkmcnt(0)
    v_mfma_f32_32x32x16_bf16 v[56:71], v[88:91], v[124:127], v[56:71]
    s_waitcnt vmcnt(6)
    s_barrier
    ds_read_b128 v[104:107], v12 offset:12288
    ds_read_b128 v[108:111], v13 offset:12288
    ds_read_b128 v[112:115], v14 offset:12288
    v_mfma_f32_32x32x16_bf16 v[72:87], v[88:91], v[128:131], v[72:87]
    ds_read_b128 v[116:119], v15 offset:12288
    ds_read_b64_tr_b16 v[172:173], v16 offset:37888
    ds_read_b64_tr_b16 v[174:175], v16 offset:38144
    ds_read_b64_tr_b16 v[176:177], v16 offset:38912
    v_mfma_f32_32x32x16_bf16 v[40:55], v[120:123], v[88:91], v[40:55]
    ds_read_b64_tr_b16 v[178:179], v16 offset:39168
    ds_read_b64_tr_b16 v[168:169], v20 offset:36864
    ds_read_b64_tr_b16 v[170:171], v20 offset:37120
    v_mfma_f32_32x32x16_bf16 v[56:71], v[92:95], v[136:139], v[56:71]
    ds_read_b64_tr_b16 v[184:185], v17 offset:37888
    ds_read_b64_tr_b16 v[186:187], v17 offset:38144
    ds_read_b64_tr_b16 v[196:197], v18 offset:37888
    v_mfma_f32_32x32x16_bf16 v[72:87], v[92:95], v[140:143], v[72:87]
    ds_read_b64_tr_b16 v[198:199], v18 offset:38144
    ds_read_b64_tr_b16 v[208:209], v19 offset:37888
    ds_read_b64_tr_b16 v[210:211], v19 offset:38144
    v_mfma_f32_32x32x16_bf16 v[40:55], v[132:135], v[92:95], v[40:55]
    ds_read_b64_tr_b16 v[188:189], v17 offset:38912
    ds_read_b64_tr_b16 v[190:191], v17 offset:39168
    ds_read_b64_tr_b16 v[200:201], v18 offset:38912
    s_waitcnt lgkmcnt(9)
    v_dot2c_f32_bf16 v26, v168, v29
    v_dot2c_f32_bf16 v27, v172, v29
    v_dot2c_f32_bf16 v28, v176, v29
    v_dot2c_f32_bf16 v26, v169, v29
    v_dot2c_f32_bf16 v27, v173, v29
    v_dot2c_f32_bf16 v28, v177, v29
    v_dot2c_f32_bf16 v26, v170, v29
    v_dot2c_f32_bf16 v27, v174, v29
    v_dot2c_f32_bf16 v28, v178, v29
    v_dot2c_f32_bf16 v26, v171, v29
    v_dot2c_f32_bf16 v27, v175, v29
    v_dot2c_f32_bf16 v28, v179, v29
    v_dot2c_f32_bf16 v24, v104, v29
    v_dot2c_f32_bf16 v25, v104, v104
    v_dot2c_f32_bf16 v24, v105, v29
    v_dot2c_f32_bf16 v25, v105, v105
    v_dot2c_f32_bf16 v24, v106, v29
    v_dot2c_f32_bf16 v25, v106, v106
    v_dot2c_f32_bf16 v24, v107, v29
    v_dot2c_f32_bf16 v25, v107, v107
    v_dot2c_f32_bf16 v24, v108, v29
    v_dot2c_f32_bf16 v25, v108, v108
    v_dot2c_f32_bf16 v24, v109, v29
    v_dot2c_f32_bf16 v25, v109, v109
    v_dot2c_f32_bf16 v24, v110, v29
    v_dot2c_f32_bf16 v25, v110, v110
    v_dot2c_f32_bf16 v24, v111, v29
    v_dot2c_f32_bf16 v25, v111, v111
    v_dot2c_f32_bf16 v24, v112, v29
    v_dot2c_f32_bf16 v25, v112, v112
    v_dot2c_f32_bf16 v24, v113, v29
    v_dot2c_f32_bf16 v25, v113, v113
    v_dot2c_f32_bf16 v24, v114, v29
    v_dot2c_f32_bf16 v25, v114, v114
    v_dot2c_f32_bf16 v24, v115, v29
    v_dot2c_f32_bf16 v25, v115, v115
    v_dot2c_f32_bf16 v24, v116, v29
    v_dot2c_f32_bf16 v25, v116, v116
    v_dot2c_f32_bf16 v24, v117, v29
    v_dot2c_f32_bf16 v25, v117, v117
    v_dot2c_f32_bf16 v24, v118, v29
    v_dot2c_f32_bf16 v25, v118, v118
    v_dot2c_f32_bf16 v24, v119, v29
    v_dot2c_f32_bf16 v25, v119, v119
    v_mfma_f32_32x32x16_bf16 v[56:71], v[96:99], v[148:151], v[56:71]
    v_mov_b32 v32, v26
    v_permlane32_swap_b32 v27, v28
    v_mov_b32 v30, v24
    v_mov_b32 v31, v25
    v_permlane32_swap_b32 v26, v32
    v_add_f32 v27, v27, v28
    v_mfma_f32_32x32x16_bf16 v[56:71], v[100:103], v[160:163], v[56:71]
    v_permlane32_swap_b32 v24, v30
    v_permlane32_swap_b32 v25, v31
    v_add_f32 v26, v26, v32
    v_add_f32 v24, v24, v30
    v_add_f32 v25, v25, v31
    v_mul_f32 v24, 0x3b000000, v24
    v_mfma_f32_32x32x16_bf16 v[56:71], v[104:107], v[172:175], v[56:71]
    s_waitcnt lgkmcnt(3)
    ds_write_b32 v227, v26 offset:0
    ds_write_b32 v227, v27 offset:128
    v_mul_f32 v25, 0x3b000000, v25
    v_fma_f32 v25, -v24, v24, v25
    v_max_f32 v25, 0, v25
    v_add_f32 v25, 0x3727c5ac, v25
    v_mfma_f32_32x32x16_bf16 v[56:71], v[108:111], v[184:187], v[56:71]
    ds_read_b64_tr_b16 v[202:203], v18 offset:39168
    ds_read_b64_tr_b16 v[212:213], v19 offset:38912
    ds_read_b64_tr_b16 v[214:215], v19 offset:39168
    v_mul_f32 v25, 0x3ef5fdf0, v25
    v_rsq_f32 v25, v25
    v_mfma_f32_32x32x16_bf16 v[56:71], v[112:115], v[196:199], v[56:71]
    ds_read_b64_tr_b16 v[180:181], v21 offset:36864
    ds_read_b64_tr_b16 v[182:183], v21 offset:37120
    ds_read_b64_tr_b16 v[192:193], v22 offset:36864
    ds_read_b64_tr_b16 v[194:195], v22 offset:37120
    ds_read_b64_tr_b16 v[204:205], v23 offset:36864
    ds_read_b64_tr_b16 v[206:207], v23 offset:37120
    v_mfma_f32_32x32x16_bf16 v[56:71], v[116:119], v[208:211], v[56:71]
    s_waitcnt lgkmcnt(9)
    s_barrier
    ds_write2_b32 v224, v24, v25 offset1:32
    ds_read2_b32 v[88:89], v225 offset0:32 offset1:64
    ds_read2_b32 v[90:91], v225 offset0:128 offset1:160
    ds_read2_b32 v[92:93], v233 offset0:32 offset1:64
    ds_read2_b32 v[94:95], v233 offset0:128 offset1:160
    v_mfma_f32_32x32x16_bf16 v[40:55], v[144:147], v[96:99], v[40:55]
    ds_read_b128 v[120:123], v226 offset:12288
    ds_read_b128 v[124:127], v226 offset:12320
    ds_read_b128 v[128:131], v226 offset:12352
    ds_read_b128 v[132:135], v226 offset:12384
    v_mfma_f32_32x32x16_bf16 v[72:87], v[96:99], v[152:155], v[72:87]
    s_waitcnt lgkmcnt(4)
    v_add_f32 v88, v88, v90
    v_add_f32 v92, v92, v94
    v_add_f32 v89, v89, v91
    v_add_f32 v93, v93, v95
    v_add_f32 v27, v88, v92
    v_add_f32 v28, v89, v93
    v_mfma_f32_32x32x16_bf16 v[40:55], v[156:159], v[100:103], v[40:55]
    s_waitcnt lgkmcnt(0)
    ds_read_b128 v[136:139], v226 offset:12416
    ds_read_b128 v[140:143], v226 offset:12448
    ds_read_b128 v[144:147], v226 offset:12480
    ds_read_b128 v[148:151], v226 offset:12512
    v_fma_f32 v56, -v120, v27, v56
    v_fma_f32 v57, -v121, v27, v57
    v_mfma_f32_32x32x16_bf16 v[72:87], v[100:103], v[164:167], v[72:87]
    ds_read2_b32 v[32:33], v225 offset0:0 offset1:96
    ds_read2_b32 v[34:35], v233 offset0:0 offset1:96
    v_fma_f32 v58, -v122, v27, v58
    v_fma_f32 v59, -v123, v27, v59
    v_fma_f32 v60, -v124, v27, v60
    v_fma_f32 v61, -v125, v27, v61
    v_mfma_f32_32x32x16_bf16 v[72:87], v[104:107], v[176:179], v[72:87]
    v_fma_f32 v62, -v126, v27, v62
    v_fma_f32 v63, -v127, v27, v63
    v_fma_f32 v64, -v128, v27, v64
    v_fma_f32 v65, -v129, v27, v65
    v_fma_f32 v66, -v130, v27, v66
    v_fma_f32 v67, -v131, v27, v67
    v_mfma_f32_32x32x16_bf16 v[72:87], v[108:111], v[188:191], v[72:87]
    s_waitcnt lgkmcnt(0)
    v_add_f32 v32, v32, v33
    v_add_f32 v34, v34, v35
    v_add_f32 v26, v32, v34
    v_fma_f32 v68, -v132, v27, v68
    v_fma_f32 v69, -v133, v27, v69
    v_fma_f32 v70, -v134, v27, v70
    v_mfma_f32_32x32x16_bf16 v[72:87], v[112:115], v[200:203], v[72:87]
    ds_write_b32 v224, v26 offset:256
    ds_read_b128 v[152:155], v226 offset:12544
    ds_read_b128 v[156:159], v226 offset:12576
    ds_read_b128 v[160:163], v226 offset:12608
    ds_read_b128 v[164:167], v226 offset:12640
    v_fma_f32 v71, -v135, v27, v71
    v_mfma_f32_32x32x16_bf16 v[72:87], v[116:119], v[212:215], v[72:87]
    v_fma_f32 v56, v56, v136, s80
    v_fma_f32 v57, v57, v137, s80
    v_fma_f32 v58, v58, v138, s80
    v_fma_f32 v59, v59, v139, s80
    v_fma_f32 v60, v60, v140, s80
    v_fma_f32 v61, v61, v141, s80
    v_mfma_f32_32x32x16_bf16 v[40:55], v[168:171], v[104:107], v[40:55]
    v_fma_f32 v62, v62, v142, s80
    v_fma_f32 v63, v63, v143, s80
    v_fma_f32 v64, v64, v144, s80
    v_fma_f32 v65, v65, v145, s80
    v_fma_f32 v66, v66, v146, s80
    v_fma_f32 v67, v67, v147, s80
    v_mfma_f32_32x32x16_bf16 v[40:55], v[180:183], v[108:111], v[40:55]
    v_fma_f32 v68, v68, v148, s80
    v_fma_f32 v69, v69, v149, s80
    v_fma_f32 v70, v70, v150, s80
    v_fma_f32 v71, v71, v151, s80
    v_exp_f32_e64 v88, v56 clamp
    v_max_f32 v56, s80, v56
    v_mfma_f32_32x32x16_bf16 v[40:55], v[192:195], v[112:115], v[40:55]
    v_exp_f32_e64 v89, v57 clamp
    v_max_f32 v57, s80, v57
    v_exp_f32_e64 v90, v58 clamp
    v_max_f32 v58, s80, v58
    v_exp_f32_e64 v91, v59 clamp
    v_max_f32 v59, s80, v59
    v_mfma_f32_32x32x16_bf16 v[40:55], v[204:207], v[116:119], v[40:55]
    v_exp_f32_e64 v92, v60 clamp
    v_max_f32 v60, s80, v60
    v_exp_f32_e64 v93, v61 clamp
    v_max_f32 v61, s80, v61
    v_exp_f32_e64 v94, v62 clamp
    v_max_f32 v62, s80, v62
    s_and_b32 s76, s88, 0x3c0
    s_mul_i32 s76, s76, 15
    s_add_u32 s76, s76, s88
    s_add_u32 s76, s76, 2097152
    buffer_store_dwordx4 v[252:255], v1, s[60:63], s76 offen sc1
    v_exp_f32_e64 v95, v63 clamp
    v_max_f32 v63, s80, v63
    v_exp_f32_e64 v96, v64 clamp
    v_max_f32 v64, s80, v64
    v_exp_f32_e64 v97, v65 clamp
    v_max_f32 v65, s80, v65
    v_exp_f32_e64 v98, v66 clamp
    v_max_f32 v66, s80, v66
    v_exp_f32_e64 v99, v67 clamp
    v_max_f32 v67, s80, v67
    v_exp_f32_e64 v100, v68 clamp
    v_max_f32 v68, s80, v68
    v_exp_f32_e64 v101, v69 clamp
    v_max_f32 v69, s80, v69
    v_exp_f32_e64 v102, v70 clamp
    v_max_f32 v70, s80, v70
    v_exp_f32_e64 v103, v71 clamp
    v_max_f32 v71, s80, v71
    v_pk_fma_f32 v[72:73], v[120:121], v[28:29], v[72:73] op_sel_hi:[1,0,1] neg_lo:[1,0,0] neg_hi:[1,0,0]
    v_pk_fma_f32 v[74:75], v[122:123], v[28:29], v[74:75] op_sel_hi:[1,0,1] neg_lo:[1,0,0] neg_hi:[1,0,0]
    v_pk_fma_f32 v[76:77], v[124:125], v[28:29], v[76:77] op_sel_hi:[1,0,1] neg_lo:[1,0,0] neg_hi:[1,0,0]
    v_pk_fma_f32 v[78:79], v[126:127], v[28:29], v[78:79] op_sel_hi:[1,0,1] neg_lo:[1,0,0] neg_hi:[1,0,0]
    s_add_u32 s76, s76, 16384
    buffer_store_dwordx4 v[252:255], v1, s[60:63], s76 offen sc1
    v_pk_fma_f32 v[80:81], v[128:129], v[28:29], v[80:81] op_sel_hi:[1,0,1] neg_lo:[1,0,0] neg_hi:[1,0,0]
    v_pk_fma_f32 v[82:83], v[130:131], v[28:29], v[82:83] op_sel_hi:[1,0,1] neg_lo:[1,0,0] neg_hi:[1,0,0]
    v_pk_fma_f32 v[84:85], v[132:133], v[28:29], v[84:85] op_sel_hi:[1,0,1] neg_lo:[1,0,0] neg_hi:[1,0,0]
    v_pk_fma_f32 v[86:87], v[134:135], v[28:29], v[86:87] op_sel_hi:[1,0,1] neg_lo:[1,0,0] neg_hi:[1,0,0]
    v_pk_mul_f32 v[72:73], v[72:73], v[136:137]
    v_pk_mul_f32 v[74:75], v[74:75], v[138:139]
    v_pk_mul_f32 v[76:77], v[76:77], v[140:141]
    v_pk_mul_f32 v[78:79], v[78:79], v[142:143]
    v_pk_mul_f32 v[80:81], v[80:81], v[144:145]
    v_pk_mul_f32 v[82:83], v[82:83], v[146:147]
    v_pk_mul_f32 v[84:85], v[84:85], v[148:149]
    v_pk_mul_f32 v[86:87], v[86:87], v[150:151]
    v_pk_fma_f32 v[56:57], v[56:57], s[86:87], v[88:89] op_sel_hi:[1,0,1]
    v_pk_fma_f32 v[58:59], v[58:59], s[86:87], v[90:91] op_sel_hi:[1,0,1]
    v_pk_fma_f32 v[60:61], v[60:61], s[86:87], v[92:93] op_sel_hi:[1,0,1]
    v_pk_fma_f32 v[62:63], v[62:63], s[86:87], v[94:95] op_sel_hi:[1,0,1]
    v_pk_fma_f32 v[64:65], v[64:65], s[86:87], v[96:97] op_sel_hi:[1,0,1]
    v_pk_fma_f32 v[66:67], v[66:67], s[86:87], v[98:99] op_sel_hi:[1,0,1]
    v_pk_fma_f32 v[68:69], v[68:69], s[86:87], v[100:101] op_sel_hi:[1,0,1]
    v_pk_fma_f32 v[70:71], v[70:71], s[86:87], v[102:103] op_sel_hi:[1,0,1]
    v_cvt_pk_bf16_f32 v184, v56, v57
    v_cvt_pk_bf16_f32 v185, v58, v59
    s_lshr_b32 s76, s88, 15
    s_lshl_b32 s76, s76, 10
    s_and_b32 s81, s88, 0x300
    s_add_u32 s76, s76, s81
    s_lshl2_add_u32 s76, s76, 11534336
    buffer_store_dword v252, v230, s[60:63], s76 offen sc1
    v_cvt_pk_bf16_f32 v186, v60, v61
    v_cvt_pk_bf16_f32 v187, v62, v63
    v_cvt_pk_bf16_f32 v188, v64, v65
    v_cvt_pk_bf16_f32 v189, v66, v67
    v_cvt_pk_bf16_f32 v190, v68, v69
    v_cvt_pk_bf16_f32 v191, v70, v71
    v_cvt_pk_bf16_f32 v192, v72, v73
    v_cvt_pk_bf16_f32 v193, v74, v75
    v_cvt_pk_bf16_f32 v194, v76, v77
    v_cvt_pk_bf16_f32 v195, v78, v79
    v_cvt_pk_bf16_f32 v196, v80, v81
    v_cvt_pk_bf16_f32 v197, v82, v83
    v_cvt_pk_bf16_f32 v198, v84, v85
    v_cvt_pk_bf16_f32 v199, v86, v87
    v_permlane16_swap_b32 v184, v188
    v_permlane16_swap_b32 v185, v189
    v_permlane16_swap_b32 v186, v190
    v_permlane16_swap_b32 v187, v191
    v_permlane16_swap_b32 v192, v196
    v_permlane16_swap_b32 v193, v197
    v_permlane16_swap_b32 v194, v198
    v_permlane16_swap_b32 v195, v199
    s_waitcnt lgkmcnt(0)
    v_mfma_f32_16x16x32_bf16 v[208:211], v[184:187], v[236:239], 0
    v_fma_f32 v40, -v24, v152, v40
    v_fma_f32 v41, -v24, v153, v41
    v_mfma_f32_16x16x32_bf16 v[212:215], v[188:191], v[236:239], 0
    v_fma_f32 v42, -v24, v154, v42
    v_fma_f32 v43, -v24, v155, v43
    v_mfma_f32_16x16x32_bf16 v[200:203], v[184:187], v[192:195], 0
    v_fma_f32 v44, -v24, v156, v44
    v_fma_f32 v45, -v24, v157, v45
    v_mfma_f32_16x16x32_bf16 v[204:207], v[188:191], v[196:199], 0
    v_fma_f32 v46, -v24, v158, v46
    v_fma_f32 v47, -v24, v159, v47
    v_fma_f32 v48, -v24, v160, v48
    v_fma_f32 v49, -v24, v161, v49
    s_mov_b32 exec_lo, 0x00010001
    s_mov_b32 exec_hi, 0x00010001
    ds_write_b128 v229, v[208:211] offset:15360
    ds_write_b128 v229, v[212:215] offset:15424
    s_mov_b64 exec, -1
    ds_write_b128 v228, v[200:203] offset:13312
    ds_write_b128 v228, v[204:207] offset:14336
    v_pk_fma_f32 v[50:51], v[24:25], v[162:163], v[50:51] op_sel_hi:[0,1,1] neg_lo:[1,0,0] neg_hi:[1,0,0]
    v_pk_fma_f32 v[52:53], v[24:25], v[164:165], v[52:53] op_sel_hi:[0,1,1] neg_lo:[1,0,0] neg_hi:[1,0,0]
    v_pk_fma_f32 v[54:55], v[24:25], v[166:167], v[54:55] op_sel_hi:[0,1,1] neg_lo:[1,0,0] neg_hi:[1,0,0]
    v_pk_fma_f32 v[40:41], v[40:41], v[24:25], s[80:81] op_sel:[0,1,0] op_sel_hi:[1,1,0]
    v_pk_fma_f32 v[42:43], v[42:43], v[24:25], s[80:81] op_sel:[0,1,0] op_sel_hi:[1,1,0]
    v_pk_fma_f32 v[44:45], v[44:45], v[24:25], s[80:81] op_sel:[0,1,0] op_sel_hi:[1,1,0]
    v_pk_fma_f32 v[46:47], v[46:47], v[24:25], s[80:81] op_sel:[0,1,0] op_sel_hi:[1,1,0]
    v_pk_fma_f32 v[48:49], v[48:49], v[24:25], s[80:81] op_sel:[0,1,0] op_sel_hi:[1,1,0]
    v_pk_fma_f32 v[50:51], v[50:51], v[24:25], s[80:81] op_sel:[0,1,0] op_sel_hi:[1,1,0]
    v_pk_fma_f32 v[52:53], v[52:53], v[24:25], s[80:81] op_sel:[0,1,0] op_sel_hi:[1,1,0]
    v_pk_fma_f32 v[54:55], v[54:55], v[24:25], s[80:81] op_sel:[0,1,0] op_sel_hi:[1,1,0]
    s_waitcnt lgkmcnt(0)
    s_barrier
    ds_read2st64_b32 v[200:201], v231 offset0:0 offset1:64
    ds_read2st64_b32 v[202:203], v231 offset0:128 offset1:192
    ds_read2st64_b32 v[204:205], v231 offset0:4 offset1:68
    ds_read2st64_b32 v[206:207], v231 offset0:132 offset1:196
    ds_read2st64_b32 v[208:209], v232 offset0:8 offset1:72
    ds_read2st64_b32 v[210:211], v232 offset0:136 offset1:200
    s_waitcnt vmcnt(7)
    ds_read2st64_b64 v[240:243], v249 offset1:2
    ds_read2st64_b64 v[244:247], v250 offset1:2
    s_mul_i32 s78, s71, 2176
    s_add_u32 s78, s78, 11796480
    s_waitcnt vmcnt(6)
LA_chk:
    v_cmp_ne_u32 vcc, 1, v216
    s_cbranch_vccnz LX_dbg
    v_exp_f32_e64 v88, v40 clamp
    v_max_f32 v40, s80, v40
    v_exp_f32_e64 v89, v41 clamp
    v_max_f32 v41, s80, v41
    v_exp_f32_e64 v90, v42 clamp
    v_max_f32 v42, s80, v42
    v_exp_f32_e64 v91, v43 clamp
    v_max_f32 v43, s80, v43
    v_exp_f32_e64 v92, v44 clamp
    v_max_f32 v44, s80, v44
    v_exp_f32_e64 v93, v45 clamp
    v_max_f32 v45, s80, v45
    v_exp_f32_e64 v94, v46 clamp
    v_max_f32 v46, s80, v46
    v_exp_f32_e64 v95, v47 clamp
    v_max_f32 v47, s80, v47
    s_waitcnt lgkmcnt(0)
    v_pk_add_f32 v[200:201], v[200:201], v[202:203]
    v_pk_add_f32 v[204:205], v[204:205], v[206:207]
    v_pk_add_f32 v[208:209], v[208:209], v[210:211]
    v_add_f32 v200, v200, v201
    v_add_f32 v204, v204, v205
    v_add_f32 v208, v208, v209
    s_cmp_eq_u32 s3, 0
    buffer_atomic_add_f32 v200, v230, s[60:63], s78 offen
    buffer_atomic_add_f32 v204, v230, s[60:63], s78 offen offset:1024
    s_cbranch_scc0 LA_noat
    s_mov_b32 exec_hi, 0
    buffer_atomic_add_f32 v208, v230, s[60:63], s78 offen offset:2048
    s_mov_b32 exec_hi, -1
LA_noat:
    s_lshl_b32 s79, s71, 11
    s_add_u32 s78, s72, s79
    v_exp_f32_e64 v96, v48 clamp
    v_max_f32 v48, s80, v48
    v_exp_f32_e64 v97, v49 clamp
    v_max_f32 v49, s80, v49
    v_exp_f32_e64 v98, v50 clamp
    v_max_f32 v50, s80, v50
    v_exp_f32_e64 v99, v51 clamp
    v_max_f32 v51, s80, v51
    v_exp_f32_e64 v100, v52 clamp
    v_max_f32 v52, s80, v52
    v_exp_f32_e64 v101, v53 clamp
    v_max_f32 v53, s80, v53
    v_exp_f32_e64 v102, v54 clamp
    v_max_f32 v54, s80, v54
    v_exp_f32_e64 v103, v55 clamp
    v_max_f32 v55, s80, v55
    v_pk_fma_f32 v[40:41], v[40:41], s[86:87], v[88:89] op_sel_hi:[1,0,1]
    v_pk_fma_f32 v[42:43], v[42:43], s[86:87], v[90:91] op_sel_hi:[1,0,1]
    v_pk_fma_f32 v[44:45], v[44:45], s[86:87], v[92:93] op_sel_hi:[1,0,1]
    v_pk_fma_f32 v[46:47], v[46:47], s[86:87], v[94:95] op_sel_hi:[1,0,1]
    v_pk_fma_f32 v[48:49], v[48:49], s[86:87], v[96:97] op_sel_hi:[1,0,1]
    v_pk_fma_f32 v[50:51], v[50:51], s[86:87], v[98:99] op_sel_hi:[1,0,1]
    v_pk_fma_f32 v[52:53], v[52:53], s[86:87], v[100:101] op_sel_hi:[1,0,1]
    v_pk_fma_f32 v[54:55], v[54:55], s[86:87], v[102:103] op_sel_hi:[1,0,1]
    v_cvt_pk_bf16_f32 v184, v40, v41
    v_cvt_pk_bf16_f32 v185, v42, v43
    v_cvt_pk_bf16_f32 v186, v44, v45
    v_cvt_pk_bf16_f32 v187, v46, v47
    v_cvt_pk_bf16_f32 v188, v48, v49
    v_cvt_pk_bf16_f32 v189, v50, v51
    v_cvt_pk_bf16_f32 v190, v52, v53
    v_cvt_pk_bf16_f32 v191, v54, v55
    buffer_store_dwordx4 v[184:187], v1, s[60:63], s78 offen sc1
    buffer_store_dwordx4 v[188:191], v1, s[60:63], s78 offen offset:1024 sc1
    s_add_u32 m0, s85, 0
    s_add_u32 s77, s84, 0
    buffer_load_dwordx4 v220, s[44:47], s77 offen offset:0 lds
    s_lshl4_add_u32 s79, s71, s70
    s_lshl_b32 s79, s79, 3
    s_add_u32 s79, s79, 11831296
    s_mov_b64 s[36:37], s[60:61]
    s_cmp_eq_u32 s3, 0
    s_cselect_b32 s38, 13631488, 0
    v_mov_b32 v39, 1
    v_bfe_u32 v100, v0, 2, 3
    v_bfe_u32 v101, v0, 2, 2
    buffer_load_dwordx4 v221, s[44:47], s77 offen offset:1024 lds
    v_bfe_u32 v102, v0, 4, 1
    v_lshl_add_u32 v101, v102, 3, v101
    v_lshlrev_b32 v101, 8, v101
    v_and_b32 v102, 3, v0
    v_lshl_add_u32 v101, v102, 3, v101
    s_lshl_b32 s76, s3, 1
    v_xor_b32 v100, s76, v100
    buffer_load_dwordx4 v222, s[44:47], s77 offen offset:2048 lds
    v_lshrrev_b32 v103, 2, v0
    v_lshlrev_b32 v103, 8, v103
    v_lshl_add_u32 v103, v102, 3, v103
    v_lshl_add_u32 v224, v100, 5, v103
    v_xor_b32 v225, 32, v224
    v_add_u32 v226, 65536, v224
    v_add_u32 v227, 65536, v225
    buffer_load_dwordx4 v223, s[44:47], s77 offen offset:3072 lds
    v_lshl_add_u32 v101, v100, 5, v101
    v_lshrrev_b32 v102, 5, v0
    v_lshl_add_u32 v4, v102, 14, v101
    v_lshl_add_u32 v5, v102, 12, v101
    v_add_u32 v5, 102400, v5
    v_mul_u32_u24 v103, 32768, v102
    v_add_u32 v6, v103, v101
    s_add_u32 m0, s85, 16384
    s_add_u32 s77, s84, 16384
    buffer_load_dwordx4 v220, s[44:47], s77 offen offset:0 lds
    v_add_u32 v6, 65536, v6
    v_mul_u32_u24 v103, 45056, v102
    v_add_u32 v7, v103, v101
    v_add_u32 v7, 69632, v7
    v_mul_u32_u24 v103, 57344, v102
    v_add_u32 v8, v103, v101
    v_add_u32 v8, 73728, v8
    buffer_load_dwordx4 v221, s[44:47], s77 offen offset:1024 lds
    v_mul_u32_u24 v103, 69632, v102
    v_add_u32 v9, v103, v101
    v_add_u32 v9, 77824, v9
    v_xor_b32 v10, 32, v4
    v_xor_b32 v11, 32, v5
    v_xor_b32 v12, 32, v6
    v_xor_b32 v13, 32, v7
    buffer_load_dwordx4 v222, s[44:47], s77 offen offset:2048 lds
    v_xor_b32 v14, 32, v8
    v_xor_b32 v15, 32, v9
    s_mov_b32 s86, s70
    s_lshr_b32 s70, s88, 15
    s_lshr_b32 s71, s69, 3
    s_and_b32 s76, s68, 1
    s_mul_i32 s76, s76, 7
    buffer_load_dwordx4 v223, s[44:47], s77 offen offset:3072 lds
    s_lshr_b32 s87, s69, 2
    s_add_u32 s87, s87, s76
    v_and_b32 v100, 15, v0
    v_lshrrev_b32 v101, 4, v0
    v_lshlrev_b32 v102, 1, v101
    v_xor_b32 v102, v100, v102
    v_lshlrev_b32 v102, 4, v102
    s_add_u32 m0, s85, 32768
    s_add_u32 s77, s84, 32768
    buffer_load_dwordx4 v220, s[44:47], s77 offen offset:0 lds
    v_mul_u32_u24 v103, 3584, v101
    v_add_u32 v16, v103, v102
    v_xor_b32 v102, 128, v102
    v_add_u32 v17, v103, v102
    v_add_u32 v17, 13312, v17
    v_add_u32 v18, 26624, v16
    v_add_u32 v19, 26624, v17
    buffer_load_dwordx4 v221, s[44:47], s77 offen offset:1024 lds
    s_and_b32 s76, s3, 1
    s_mul_i32 s88, s76, 229376
    s_lshl_b32 s76, s87, 8
    s_add_u32 s88, s88, s76
    s_lshl_b32 s89, s3, 14
    v_min_u32 v105, 3, v0
    v_lshlrev_b32 v105, 11, v105
    s_cmp_lt_u32 s69, 28
    s_cbranch_scc1 LE_ni
    s_and_b32 s88, s69, 3
    s_lshl2_add_u32 s88, s88, s3
    s_lshl_b32 s88, s88, 12
    v_mov_b32 v16, v1
    v_mov_b32 v17, v1
    v_mov_b32 v18, v1
    v_mov_b32 v19, v1
LE_ni:
    s_mov_b64 exec, 0
    s_cmp_eq_u32 s3, 0
    s_cbranch_scc1 Lpad_est0
    s_cmp_eq_u32 s3, 1
    s_cbranch_scc1 Lpad_est1
    s_cmp_eq_u32 s3, 2
    s_cbranch_scc1 Lpad_est2
    s_branch Lpad_est3
Lpad_retst:
    s_mov_b64 exec, -1
    s_waitcnt vmcnt(10)
    s_barrier
    buffer_store_dword v39, v105, s[36:39], s79 offen sc1
    buffer_load_dwordx4 v222, s[44:47], s77 offen offset:2048 lds
    s_movk_i32 s76, 2176
    v_bfe_u32 v30, v0, 1, 1
    v_bfe_u32 v31, v0, 3, 1
    v_lshl_add_u32 v30, v31, 1, v30
    buffer_load_dwordx4 v223, s[44:47], s77 offen offset:3072 lds
    v_and_b32 v31, 48, v0
    v_mad_u32_u24 v30, v30, s76, v31
    v_and_b32 v31, 1, v0
    s_add_u32 m0, s85, 49152
    s_add_u32 s77, s84, 49152
    buffer_load_dwordx4 v220, s[44:47], s77 offen offset:0 lds
    v_lshl_add_u32 v30, v31, 6, v30
    s_mul_i32 s72, s3, 8704
    s_add_u32 s72, s72, 11796480
    s_add_u32 s73, s72, 4352
    buffer_load_dwordx4 v221, s[44:47], s77 offen offset:1024 lds
    s_lshl_b32 s81, s70, 15
    s_lshl_b32 s78, s3, 13
    s_add_u32 s81, s81, s78
    buffer_load_dwordx4 v222, s[44:47], s77 offen offset:2048 lds
    s_add_u32 s75, s81, 4096
    s_and_b32 s82, s2, 3
    s_lshl2_add_u32 s82, s82, s3
    s_lshl_b32 s82, s82, 9
    buffer_load_dwordx4 v223, s[44:47], s77 offen offset:3072 lds
    s_add_u32 s82, s82, 11831296
    s_add_u32 s78, s78, 131072
    v_lshlrev_b32 v31, 3, v0
    s_add_u32 m0, s74, 0
    s_add_u32 s77, s84, 81920
    buffer_load_dwordx4 v220, s[44:47], s77 offen offset:0 lds
    v_mov_b32 v29, 0x3fb8aa3b
    v_add_u32 v32, s78, v1
    v_and_b32 v33, 15, v0
    buffer_load_dwordx4 v221, s[44:47], s77 offen offset:1024 lds
    v_lshrrev_b32 v34, 4, v0
    v_and_b32 v28, 1, v34
    v_lshl_add_u32 v28, v33, 1, v28
    v_and_b32 v36, 32, v0
    buffer_load_dwordx4 v222, s[44:47], s77 offen offset:2048 lds
    v_add_lshl_u32 v28, v28, v36, 2
    v_lshlrev_b32 v34, 9, v34
    v_lshl_add_u32 v33, v33, 4, v34
    buffer_load_dwordx4 v223, s[44:47], s77 offen offset:3072 lds
    v_add_u32 v33, 131072, v33
    v_lshlrev_b32 v200, 16, v240
    v_and_b32 v201, 0xffff0000, v240
    v_lshlrev_b32 v202, 16, v241
    s_add_u32 m0, s74, 4096
    s_add_u32 s77, s84, 98304
    buffer_load_dwordx4 v220, s[44:47], s77 offen offset:0 lds
    v_and_b32 v203, 0xffff0000, v241
    v_lshlrev_b32 v204, 16, v244
    v_and_b32 v205, 0xffff0000, v244
    buffer_load_dwordx4 v221, s[44:47], s77 offen offset:1024 lds
    v_lshlrev_b32 v206, 16, v245
    v_and_b32 v207, 0xffff0000, v245
    v_lshlrev_b32 v208, 16, v242
    v_and_b32 v209, 0xffff0000, v242
    buffer_load_dwordx4 v222, s[44:47], s77 offen offset:2048 lds
    v_lshlrev_b32 v210, 16, v243
    v_and_b32 v211, 0xffff0000, v243
    v_lshlrev_b32 v212, 16, v246
    buffer_load_dwordx4 v223, s[44:47], s77 offen offset:3072 lds
    v_and_b32 v213, 0xffff0000, v246
    v_lshlrev_b32 v214, 16, v247
    v_and_b32 v215, 0xffff0000, v247
    s_waitcnt vmcnt(8)
    s_barrier
    s_add_u32 m0, s74, 8192
    s_add_u32 s77, s84, 114688
    buffer_load_dwordx4 v220, s[44:47], s77 offen offset:0 lds
    ds_read_b64_tr_b16 a[128:129], v4 offset:0
    ds_read_b64_tr_b16 a[130:131], v4 offset:1024
    ds_read_b64_tr_b16 a[192:193], v10 offset:0
    ds_read_b64_tr_b16 a[194:195], v10 offset:1024
    buffer_load_dwordx4 v221, s[44:47], s77 offen offset:1024 lds
    ds_read_b64_tr_b16 a[132:133], v4 offset:32768
    ds_read_b64_tr_b16 a[134:135], v4 offset:33792
    ds_read_b64_tr_b16 a[196:197], v10 offset:32768
    ds_read_b64_tr_b16 a[198:199], v10 offset:33792
    buffer_load_dwordx4 v222, s[44:47], s77 offen offset:2048 lds
    ds_read_b64_tr_b16 a[144:145], v4 offset:4096
    ds_read_b64_tr_b16 a[146:147], v4 offset:5120
    ds_read_b64_tr_b16 a[208:209], v10 offset:4096
    ds_read_b64_tr_b16 a[210:211], v10 offset:5120
    buffer_load_dwordx4 v223, s[44:47], s77 offen offset:3072 lds
    ds_read_b64_tr_b16 a[148:149], v4 offset:36864
    ds_read_b64_tr_b16 a[150:151], v4 offset:37888
    ds_read_b64_tr_b16 a[212:213], v10 offset:36864
    ds_read_b64_tr_b16 a[214:215], v10 offset:37888
    s_add_u32 m0, s85, 65536
    s_add_u32 s77, s84, 65536
    buffer_load_dwordx4 v220, s[44:47], s77 offen offset:0 lds
    ds_read_b64_tr_b16 a[160:161], v4 offset:8192
    ds_read_b64_tr_b16 a[162:163], v4 offset:9216
Lpad_ec02:
Lpad_3:
    s_cbranch_execz Lpad_retc0
    ds_read_b64_tr_b16 a[224:225], v10 offset:8192
    ds_read_b64_tr_b16 a[226:227], v10 offset:9216
    buffer_load_dwordx4 v221, s[44:47], s77 offen offset:1024 lds
    ds_read_b64_tr_b16 a[164:165], v4 offset:40960
    ds_read_b64_tr_b16 a[166:167], v4 offset:41984
    ds_read_b64_tr_b16 a[228:229], v10 offset:40960
    ds_read_b64_tr_b16 a[230:231], v10 offset:41984
    buffer_load_dwordx4 v222, s[44:47], s77 offen offset:2048 lds
    ds_read_b64_tr_b16 a[176:177], v4 offset:12288
    ds_read_b64_tr_b16 a[178:179], v4 offset:13312
    ds_read_b64_tr_b16 a[240:241], v10 offset:12288
    ds_read_b64_tr_b16 a[242:243], v10 offset:13312
    buffer_load_dwordx4 v223, s[44:47], s77 offen offset:3072 lds
    ds_read_b64_tr_b16 a[180:181], v4 offset:45056
    ds_read_b64_tr_b16 a[182:183], v4 offset:46080
    ds_read_b64_tr_b16 a[244:245], v10 offset:45056
    ds_read_b64_tr_b16 a[246:247], v10 offset:46080
    s_waitcnt lgkmcnt(0)
    s_barrier
    s_add_u32 m0, s89, 0
    s_add_u32 s83, s88, 0
    buffer_load_dwordx4 v16, s[48:51], s83 offen offset:0 lds
    buffer_load_dwordx4 v17, s[48:51], s83 offen offset:1024 lds
    buffer_load_dwordx4 v18, s[48:51], s83 offen offset:2048 lds
    buffer_load_dwordx4 v19, s[48:51], s83 offen offset:3072 lds
    s_add_u32 m0, s89, 4096
    s_add_u32 s83, s88, 57344
    buffer_load_dwordx4 v16, s[48:51], s83 offen offset:0 lds
    buffer_load_dwordx4 v17, s[48:51], s83 offen offset:1024 lds
    buffer_load_dwordx4 v18, s[48:51], s83 offen offset:2048 lds
    buffer_load_dwordx4 v19, s[48:51], s83 offen offset:3072 lds
    s_add_u32 m0, s89, 8192
    s_add_u32 s83, s88, 114688
    buffer_load_dwordx4 v16, s[48:51], s83 offen offset:0 lds
    buffer_load_dwordx4 v17, s[48:51], s83 offen offset:1024 lds
    buffer_load_dword v136, v31, s[60:63], s82 offen sc1
    buffer_load_dwordx4 v18, s[48:51], s83 offen offset:2048 lds
    buffer_load_dwordx4 v19, s[48:51], s83 offen offset:3072 lds
    s_add_u32 m0, s89, 12288
    s_add_u32 s83, s88, 172032
    buffer_load_dwordx4 v16, s[48:51], s83 offen offset:0 lds
    buffer_load_dwordx4 v17, s[48:51], s83 offen offset:1024 lds
    buffer_load_dwordx4 v18, s[48:51], s83 offen offset:2048 lds
    buffer_load_dwordx4 v19, s[48:51], s83 offen offset:3072 lds
    v_lshrrev_b32 v244, 3, v0
    v_and_b32 v245, 7, v0
    v_and_b32 v246, 6, v244
    v_xor_b32 v245, v245, v246
    v_lshlrev_b32 v245, 4, v245
    v_lshl_add_u32 v35, v244, 10, v245
    v_add_u32 v36, 7168, v35
    v_add_u32 v37, 14336, v35
    v_add_u32 v38, 21504, v35
    v_mov_b32 v20, v1
    v_add_u32 v21, 65536, v1
    v_and_b32 v244, 15, v0
    v_lshlrev_b32 v22, 4, v244
    v_add_u32 v22, 147456, v22
    v_and_b32 v245, 48, v0
    v_and_b32 v246, 3, v0
    v_lshl_add_u32 v25, v246, 8, v245
    v_and_b32 v246, 4, v0
    v_lshl_add_u32 v25, v246, 1, v25
    v_and_b32 v246, 8, v0
    v_lshl_add_u32 v25, v246, 7, v25
    v_add_u32 v34, 131072, v1
    v_bfe_u32 v245, v0, 4, 1
    v_lshl_add_u32 v3, v245, 3, v34
    v_add_u32 v3, s85, v3
    s_mul_i32 s67, s3, 14
    v_min_u32 v244, 13, v0
    v_add_lshl_u32 v23, s67, v244, 2
    s_waitcnt vmcnt(6)
    v_cmp_gt_u32 vcc, 1, v136
    s_cbranch_vccnz LX_early
    buffer_load_dwordx4 v[228:231], v30, s[60:63], s72 offen offset:2048 sc1
    buffer_load_dwordx4 v[44:47], v1, s[60:63], s72 offen offset:0 sc1
    buffer_load_dwordx4 v[104:107], v1, s[60:63], s81 offen offset:0 sc1
    buffer_load_dwordx4 v[52:55], v1, s[60:63], s72 offen offset:1024 sc1
    buffer_load_dwordx4 v[108:111], v1, s[60:63], s81 offen offset:1024 sc1
    buffer_load_dwordx4 v[60:63], v1, s[60:63], s72 offen offset:2176 sc1
    s_barrier
    buffer_load_dwordx4 v[112:115], v1, s[60:63], s81 offen offset:2048 sc1
    ds_read_b64_tr_b16 a[136:137], v6 offset:0
    ds_read_b64_tr_b16 a[138:139], v6 offset:1024
    ds_read_b64_tr_b16 a[200:201], v12 offset:0
    buffer_load_dwordx4 v[68:71], v1, s[60:63], s72 offen offset:3200 sc1
    ds_read_b64_tr_b16 a[202:203], v12 offset:1024
    ds_read_b64_tr_b16 a[140:141], v5 offset:0
    ds_read_b64_tr_b16 a[142:143], v5 offset:1024
    buffer_load_dwordx4 v[116:119], v1, s[60:63], s81 offen offset:3072 sc1
    ds_read_b64_tr_b16 a[204:205], v11 offset:0
    ds_read_b64_tr_b16 a[206:207], v11 offset:1024
    ds_read_b64_tr_b16 a[152:153], v7 offset:0
    buffer_load_dwordx4 v[76:79], v1, s[60:63], s73 offen offset:0 sc1
    ds_read_b64_tr_b16 a[154:155], v7 offset:1024
    ds_read_b64_tr_b16 a[216:217], v13 offset:0
    ds_read_b64_tr_b16 a[218:219], v13 offset:1024
    buffer_load_dwordx4 v[120:123], v1, s[60:63], s75 offen offset:0 sc1
    ds_read_b64_tr_b16 a[156:157], v5 offset:16384
    ds_read_b64_tr_b16 a[158:159], v5 offset:17408
    ds_read_b64_tr_b16 a[220:221], v11 offset:16384
    buffer_load_dwordx4 v[84:87], v1, s[60:63], s73 offen offset:1024 sc1
    ds_read_b64_tr_b16 a[222:223], v11 offset:17408
    ds_read_b64_tr_b16 a[168:169], v8 offset:0
    ds_read_b64_tr_b16 a[170:171], v8 offset:1024
    buffer_load_dwordx4 v[124:127], v1, s[60:63], s75 offen offset:1024 sc1
    ds_read_b64_tr_b16 a[232:233], v14 offset:0
    ds_read_b64_tr_b16 a[234:235], v14 offset:1024
    ds_read_b64_tr_b16 a[172:173], v5 offset:32768
    buffer_load_dwordx4 v[92:95], v1, s[60:63], s73 offen offset:2176 sc1
    ds_read_b64_tr_b16 a[174:175], v5 offset:33792
    ds_read_b64_tr_b16 a[236:237], v11 offset:32768
    ds_read_b64_tr_b16 a[238:239], v11 offset:33792
    buffer_load_dwordx4 v[128:131], v1, s[60:63], s75 offen offset:2048 sc1
    ds_read_b64_tr_b16 a[184:185], v9 offset:0
    ds_read_b64_tr_b16 a[186:187], v9 offset:1024
    ds_read_b64_tr_b16 a[248:249], v15 offset:0
    buffer_load_dwordx4 v[100:103], v1, s[60:63], s73 offen offset:3200 sc1
    ds_read_b64_tr_b16 a[250:251], v15 offset:1024
    ds_read_b64_tr_b16 a[188:189], v5 offset:49152
    ds_read_b64_tr_b16 a[190:191], v5 offset:50176
    buffer_load_dwordx4 v[132:135], v1, s[60:63], s75 offen offset:3072 sc1
    ds_read_b64_tr_b16 a[252:253], v11 offset:49152
    ds_read_b64_tr_b16 a[254:255], v11 offset:50176
LB_join:
    s_lshl2_add_u32 s72, s71, s3
    s_lshl_b32 s64, s70, 15
    s_lshl_b32 s65, s72, 10
    s_add_u32 s64, s64, s65
    s_add_u32 s64, s64, 2097152
    s_add_u32 s66, s64, 16384
    s_lshl4_add_u32 s65, s70, s72
    s_lshl_b32 s65, s65, 8
    s_add_u32 s65, s65, 11534336
    s_waitcnt lgkmcnt(0)
    s_barrier
    ds_read_b64_tr_b16 a[0:1], v224 offset:0
    ds_read_b64_tr_b16 a[2:3], v224 offset:4096
    ds_read_b64_tr_b16 a[8:9], v224 offset:16384
    ds_read_b64_tr_b16 a[10:11], v224 offset:20480
    ds_read_b64_tr_b16 a[32:33], v224 offset:32768
    ds_read_b64_tr_b16 a[34:35], v224 offset:36864
    ds_read_b64_tr_b16 a[40:41], v224 offset:49152
    ds_read_b64_tr_b16 a[42:43], v224 offset:53248
    ds_read_b64_tr_b16 a[64:65], v225 offset:0
    ds_read_b64_tr_b16 a[66:67], v225 offset:4096
    ds_read_b64_tr_b16 a[72:73], v225 offset:16384
    ds_read_b64_tr_b16 a[74:75], v225 offset:20480
    ds_read_b64_tr_b16 a[96:97], v225 offset:32768
    ds_read_b64_tr_b16 a[98:99], v225 offset:36864
    ds_read_b64_tr_b16 a[104:105], v225 offset:49152
    ds_read_b64_tr_b16 a[106:107], v225 offset:53248
    s_add_u32 m0, s89, 65536
    s_add_u32 s83, s88, 458752
    buffer_load_dwordx4 v16, s[48:51], s83 offen offset:0 lds
    s_waitcnt vmcnt(15)
    v_cvt_pk_bf16_f32 v40, v44, v45
    v_cvt_pk_bf16_f32 v41, v46, v47
    v_cvt_pk_bf16_f32 v42, v228, v229
    v_cvt_pk_bf16_f32 v43, v230, v231
    s_waitcnt vmcnt(13)
    v_cvt_pk_bf16_f32 v48, v52, v53
    v_cvt_pk_bf16_f32 v49, v54, v55
    v_cvt_pk_bf16_f32 v50, v228, v229
    v_cvt_pk_bf16_f32 v51, v230, v231
    v_permlane16_swap_b32 v40, v42
    v_permlane16_swap_b32 v41, v43
    v_permlane16_swap_b32 v48, v50
    v_permlane16_swap_b32 v49, v51
    v_mfma_f32_32x32x16_bf16 v[136:151], v[40:43], v[104:107], 0
    s_waitcnt vmcnt(11)
    v_cvt_pk_bf16_f32 v56, v60, v61
    v_cvt_pk_bf16_f32 v57, v62, v63
    v_cvt_pk_bf16_f32 v58, v228, v229
    v_cvt_pk_bf16_f32 v59, v230, v231
    v_mfma_f32_32x32x16_bf16 v[152:167], v[48:51], v[108:111], 0
    s_nop 5
    v_fma_f32 v144, v144, v29, s80
    v_rcp_f32 v144, v144
    s_nop 0
    v_pk_mul_f32 v[136:137], v[136:137], v[144:145] op_sel:[0,0] op_sel_hi:[1,0]
    v_pk_mul_f32 v[138:139], v[138:139], v[144:145] op_sel:[0,0] op_sel_hi:[1,0]
    v_permlane16_swap_b32 v56, v58
    v_permlane16_swap_b32 v57, v59
    v_pk_mul_f32 v[140:141], v[140:141], v[144:145] op_sel:[0,0] op_sel_hi:[1,0]
    v_pk_mul_f32 v[142:143], v[142:143], v[144:145] op_sel:[0,0] op_sel_hi:[1,0]
    v_mfma_f32_32x32x16_bf16 v[168:183], v[56:59], v[112:115], 0
    buffer_load_dwordx4 v17, s[48:51], s83 offen offset:1024 lds
    v_cvt_pk_bf16_f32 v148, v136, v137
    v_cvt_pk_bf16_f32 v149, v138, v139
    v_cvt_pk_bf16_f32 v150, v140, v141
    v_cvt_pk_bf16_f32 v151, v142, v143
    v_fma_f32 v161, v161, v29, s80
    v_rcp_f32 v161, v161
    ds_write_b128 v32, v[148:151] offset:0
    buffer_load_dwordx4 v18, s[48:51], s83 offen offset:2048 lds
    s_waitcnt vmcnt(11)
    v_cvt_pk_bf16_f32 v64, v68, v69
    v_cvt_pk_bf16_f32 v65, v70, v71
    v_cvt_pk_bf16_f32 v66, v228, v229
    v_cvt_pk_bf16_f32 v67, v230, v231
    v_pk_mul_f32 v[152:153], v[152:153], v[160:161] op_sel:[0,1] op_sel_hi:[1,1]
    v_pk_mul_f32 v[154:155], v[154:155], v[160:161] op_sel:[0,1] op_sel_hi:[1,1]
    v_permlane16_swap_b32 v64, v66
    v_permlane16_swap_b32 v65, v67
    v_pk_mul_f32 v[156:157], v[156:157], v[160:161] op_sel:[0,1] op_sel_hi:[1,1]
    v_pk_mul_f32 v[158:159], v[158:159], v[160:161] op_sel:[0,1] op_sel_hi:[1,1]
    v_mfma_f32_32x32x16_bf16 v[184:199], v[64:67], v[116:119], 0
    buffer_load_dwordx4 v19, s[48:51], s83 offen offset:3072 lds
    v_cvt_pk_bf16_f32 v164, v152, v153
    v_cvt_pk_bf16_f32 v165, v154, v155
    v_cvt_pk_bf16_f32 v166, v156, v157
    v_cvt_pk_bf16_f32 v167, v158, v159
    v_fma_f32 v178, v178, v29, s80
    v_rcp_f32 v178, v178
    ds_write_b128 v32, v[164:167] offset:1024
    s_add_u32 m0, s89, 69632
    s_add_u32 s83, s88, 516096
    buffer_load_dwordx4 v16, s[48:51], s83 offen offset:0 lds
    s_waitcnt vmcnt(11)
    v_cvt_pk_bf16_f32 v72, v76, v77
    v_cvt_pk_bf16_f32 v73, v78, v79
    v_cvt_pk_bf16_f32 v74, v228, v229
    v_cvt_pk_bf16_f32 v75, v230, v231
    v_pk_mul_f32 v[168:169], v[168:169], v[178:179] op_sel:[0,0] op_sel_hi:[1,0]
    v_pk_mul_f32 v[170:171], v[170:171], v[178:179] op_sel:[0,0] op_sel_hi:[1,0]
    v_permlane16_swap_b32 v72, v74
    v_permlane16_swap_b32 v73, v75
    v_pk_mul_f32 v[172:173], v[172:173], v[178:179] op_sel:[0,0] op_sel_hi:[1,0]
    v_pk_mul_f32 v[174:175], v[174:175], v[178:179] op_sel:[0,0] op_sel_hi:[1,0]
    v_mfma_f32_32x32x16_bf16 v[136:151], v[72:75], v[120:123], 0
    buffer_load_dwordx4 v17, s[48:51], s83 offen offset:1024 lds
    v_cvt_pk_bf16_f32 v180, v168, v169
    v_cvt_pk_bf16_f32 v181, v170, v171
    v_cvt_pk_bf16_f32 v182, v172, v173
    v_cvt_pk_bf16_f32 v183, v174, v175
    v_fma_f32 v195, v195, v29, s80
    v_rcp_f32 v195, v195
    ds_write_b128 v32, v[180:183] offset:2048
    buffer_load_dwordx4 v18, s[48:51], s83 offen offset:2048 lds
    s_waitcnt vmcnt(11)
    v_cvt_pk_bf16_f32 v80, v84, v85
    v_cvt_pk_bf16_f32 v81, v86, v87
    v_cvt_pk_bf16_f32 v82, v228, v229
    v_cvt_pk_bf16_f32 v83, v230, v231
    v_pk_mul_f32 v[184:185], v[184:185], v[194:195] op_sel:[0,1] op_sel_hi:[1,1]
    v_pk_mul_f32 v[186:187], v[186:187], v[194:195] op_sel:[0,1] op_sel_hi:[1,1]
    v_permlane16_swap_b32 v80, v82
    v_permlane16_swap_b32 v81, v83
    v_pk_mul_f32 v[188:189], v[188:189], v[194:195] op_sel:[0,1] op_sel_hi:[1,1]
    v_pk_mul_f32 v[190:191], v[190:191], v[194:195] op_sel:[0,1] op_sel_hi:[1,1]
    v_mfma_f32_32x32x16_bf16 v[152:167], v[80:83], v[124:127], 0
    buffer_load_dwordx4 v19, s[48:51], s83 offen offset:3072 lds
    v_cvt_pk_bf16_f32 v196, v184, v185
    v_cvt_pk_bf16_f32 v197, v186, v187
    v_cvt_pk_bf16_f32 v198, v188, v189
    v_cvt_pk_bf16_f32 v199, v190, v191
    v_fma_f32 v148, v148, v29, s80
    v_rcp_f32 v148, v148
    ds_write_b128 v32, v[196:199] offset:3072
    s_add_u32 m0, s89, 73728
    s_add_u32 s83, s88, 573440
    buffer_load_dwordx4 v16, s[48:51], s83 offen offset:0 lds
    s_waitcnt vmcnt(11)
    v_cvt_pk_bf16_f32 v88, v92, v93
    v_cvt_pk_bf16_f32 v89, v94, v95
    v_cvt_pk_bf16_f32 v90, v228, v229
    v_cvt_pk_bf16_f32 v91, v230, v231
    v_pk_mul_f32 v[136:137], v[136:137], v[148:149] op_sel:[0,0] op_sel_hi:[1,0]
    v_pk_mul_f32 v[138:139], v[138:139], v[148:149] op_sel:[0,0] op_sel_hi:[1,0]
    v_permlane16_swap_b32 v88, v90
    v_permlane16_swap_b32 v89, v91
    v_pk_mul_f32 v[140:141], v[140:141], v[148:149] op_sel:[0,0] op_sel_hi:[1,0]
    v_pk_mul_f32 v[142:143], v[142:143], v[148:149] op_sel:[0,0] op_sel_hi:[1,0]
    v_mfma_f32_32x32x16_bf16 v[168:183], v[88:91], v[128:131], 0
    buffer_load_dwordx4 v17, s[48:51], s83 offen offset:1024 lds
    v_cvt_pk_bf16_f32 v148, v136, v137
    v_cvt_pk_bf16_f32 v149, v138, v139
    v_cvt_pk_bf16_f32 v150, v140, v141
    v_cvt_pk_bf16_f32 v151, v142, v143
    v_fma_f32 v165, v165, v29, s80
    v_rcp_f32 v165, v165
    ds_write_b128 v32, v[148:151] offset:4096
    buffer_load_dwordx4 v18, s[48:51], s83 offen offset:2048 lds
    s_waitcnt vmcnt(11)
    v_cvt_pk_bf16_f32 v96, v100, v101
    v_cvt_pk_bf16_f32 v97, v102, v103
    v_cvt_pk_bf16_f32 v98, v228, v229
    v_cvt_pk_bf16_f32 v99, v230, v231
    v_pk_mul_f32 v[152:153], v[152:153], v[164:165] op_sel:[0,1] op_sel_hi:[1,1]
    v_pk_mul_f32 v[154:155], v[154:155], v[164:165] op_sel:[0,1] op_sel_hi:[1,1]
    v_permlane16_swap_b32 v96, v98
    v_permlane16_swap_b32 v97, v99
    v_pk_mul_f32 v[156:157], v[156:157], v[164:165] op_sel:[0,1] op_sel_hi:[1,1]
    v_pk_mul_f32 v[158:159], v[158:159], v[164:165] op_sel:[0,1] op_sel_hi:[1,1]
    v_mfma_f32_32x32x16_bf16 v[184:199], v[96:99], v[132:135], 0
    buffer_load_dwordx4 v19, s[48:51], s83 offen offset:3072 lds
    v_cvt_pk_bf16_f32 v164, v152, v153
    v_cvt_pk_bf16_f32 v165, v154, v155
    v_cvt_pk_bf16_f32 v166, v156, v157
    v_cvt_pk_bf16_f32 v167, v158, v159
    v_fma_f32 v182, v182, v29, s80
    v_rcp_f32 v182, v182
    ds_write_b128 v32, v[164:167] offset:5120
    s_add_u32 m0, s89, 77824
    s_add_u32 s83, s88, 630784
    buffer_load_dwordx4 v16, s[48:51], s83 offen offset:0 lds
    v_pk_mul_f32 v[168:169], v[168:169], v[182:183] op_sel:[0,0] op_sel_hi:[1,0]
    v_pk_mul_f32 v[170:171], v[170:171], v[182:183] op_sel:[0,0] op_sel_hi:[1,0]
    v_pk_mul_f32 v[172:173], v[172:173], v[182:183] op_sel:[0,0] op_sel_hi:[1,0]
    v_pk_mul_f32 v[174:175], v[174:175], v[182:183] op_sel:[0,0] op_sel_hi:[1,0]
    buffer_load_dwordx4 v17, s[48:51], s83 offen offset:1024 lds
    v_cvt_pk_bf16_f32 v180, v168, v169
    v_cvt_pk_bf16_f32 v181, v170, v171
    v_cvt_pk_bf16_f32 v182, v172, v173
    v_cvt_pk_bf16_f32 v183, v174, v175
    v_fma_f32 v199, v199, v29, s80
    v_rcp_f32 v199, v199
    ds_write_b128 v32, v[180:183] offset:6144
    buffer_load_dwordx4 v18, s[48:51], s83 offen offset:2048 lds
    v_pk_mul_f32 v[184:185], v[184:185], v[198:199] op_sel:[0,1] op_sel_hi:[1,1]
    v_pk_mul_f32 v[186:187], v[186:187], v[198:199] op_sel:[0,1] op_sel_hi:[1,1]
    v_pk_mul_f32 v[188:189], v[188:189], v[198:199] op_sel:[0,1] op_sel_hi:[1,1]
    v_pk_mul_f32 v[190:191], v[190:191], v[198:199] op_sel:[0,1] op_sel_hi:[1,1]
    buffer_load_dwordx4 v19, s[48:51], s83 offen offset:3072 lds
    v_cvt_pk_bf16_f32 v196, v184, v185
    v_cvt_pk_bf16_f32 v197, v186, v187
    v_cvt_pk_bf16_f32 v198, v188, v189
    v_cvt_pk_bf16_f32 v199, v190, v191
    ds_write_b128 v32, v[196:199] offset:7168
    s_waitcnt lgkmcnt(0)
    s_barrier
    ds_read_b128 v[40:43], v33 offset:0
    ds_read_b128 v[44:47], v33 offset:2048
    ds_read_b128 v[48:51], v33 offset:4096
    ds_read_b128 v[52:55], v33 offset:6144
    ds_read_b128 v[56:59], v33 offset:8192
    ds_read_b128 v[60:63], v33 offset:10240
    ds_read_b128 v[64:67], v33 offset:12288
    ds_read_b128 v[68:71], v33 offset:14336
    ds_read_b128 v[72:75], v33 offset:16384
    ds_read_b128 v[76:79], v33 offset:18432
    ds_read_b128 v[80:83], v33 offset:20480
    ds_read_b128 v[84:87], v33 offset:22528
    s_add_u32 m0, s89, 0
    s_add_u32 s83, s88, 917504
    buffer_load_dwordx4 v16, s[48:51], s83 offen offset:0 lds
    buffer_load_dwordx4 v17, s[48:51], s83 offen offset:1024 lds
    s_waitcnt lgkmcnt(10)
    v_mfma_f32_16x16x32_bf16 v[200:203], a[128:131], v[40:43], v[200:203]
    ds_read_b128 v[88:91], v33 offset:24576
    ds_read_b64_tr_b16 a[4:5], v224 offset:8192
    v_mfma_f32_16x16x32_bf16 v[200:203], a[132:135], v[44:47], v[200:203]
    s_waitcnt lgkmcnt(10)
    ds_read_b128 v[92:95], v33 offset:26624
    ds_read_b64_tr_b16 a[6:7], v224 offset:12288
    v_mfma_f32_16x16x32_bf16 v[200:203], a[136:139], v[48:51], v[200:203]
    ds_read_b128 v[96:99], v33 offset:28672
    buffer_load_dwordx4 v18, s[48:51], s83 offen offset:2048 lds
    v_mfma_f32_16x16x32_bf16 v[200:203], a[140:143], v[52:55], v[200:203]
    s_waitcnt lgkmcnt(11)
    ds_read_b128 v[100:103], v33 offset:30720
    ds_read_b64_tr_b16 a[12:13], v224 offset:24576
    v_mfma_f32_16x16x32_bf16 v[200:203], a[144:147], v[56:59], v[200:203]
    ds_read_b128 v[104:107], v33 offset:256
    ds_read_b64_tr_b16 a[14:15], v224 offset:28672
    v_mfma_f32_16x16x32_bf16 v[200:203], a[148:151], v[60:63], v[200:203]
    s_waitcnt lgkmcnt(13)
    ds_read_b128 v[108:111], v33 offset:2304
    ds_read_b64_tr_b16 a[36:37], v224 offset:40960
    v_mfma_f32_16x16x32_bf16 v[200:203], a[152:155], v[64:67], v[200:203]
    ds_read_b128 v[112:115], v33 offset:4352
    buffer_load_dwordx4 v19, s[48:51], s83 offen offset:3072 lds
    v_mfma_f32_16x16x32_bf16 v[200:203], a[156:159], v[68:71], v[200:203]
    s_waitcnt lgkmcnt(14)
    ds_read_b128 v[116:119], v33 offset:6400
    ds_read_b64_tr_b16 a[38:39], v224 offset:45056
    v_mfma_f32_16x16x32_bf16 v[200:203], a[160:163], v[72:75], v[200:203]
    ds_read_b128 v[120:123], v33 offset:8448
    ds_read_b64_tr_b16 a[44:45], v224 offset:57344
    v_mfma_f32_16x16x32_bf16 v[200:203], a[164:167], v[76:79], v[200:203]
    s_waitcnt lgkmcnt(15)
    ds_read_b128 v[124:127], v33 offset:10496
    ds_read_b64_tr_b16 a[46:47], v224 offset:61440
    v_mfma_f32_16x16x32_bf16 v[200:203], a[168:171], v[80:83], v[200:203]
    ds_read_b128 v[128:131], v33 offset:12544
    ds_read_b64_tr_b16 a[68:69], v225 offset:8192
    v_mfma_f32_16x16x32_bf16 v[200:203], a[172:175], v[84:87], v[200:203]
    s_waitcnt lgkmcnt(15)
    s_add_u32 m0, s89, 4096
    ds_read_b128 v[132:135], v33 offset:14592
    v_mfma_f32_16x16x32_bf16 v[200:203], a[176:179], v[88:91], v[200:203]
    s_add_u32 s83, s88, 974848
    ds_read_b128 v[136:139], v33 offset:16640
    buffer_load_dwordx4 v16, s[48:51], s83 offen offset:0 lds
    v_mfma_f32_16x16x32_bf16 v[200:203], a[180:183], v[92:95], v[200:203]
    s_waitcnt lgkmcnt(15)
    ds_read_b128 v[140:143], v33 offset:18688
    ds_read_b64_tr_b16 a[70:71], v225 offset:12288
    v_mfma_f32_16x16x32_bf16 v[200:203], a[184:187], v[96:99], v[200:203]
    ds_read_b128 v[144:147], v33 offset:20736
    ds_read_b64_tr_b16 a[76:77], v225 offset:24576
    v_mfma_f32_16x16x32_bf16 v[200:203], a[188:191], v[100:103], v[200:203]
    ds_read_b128 v[148:151], v33 offset:22784
    buffer_load_dwordx4 v17, s[48:51], s83 offen offset:1024 lds
    v_mfma_f32_16x16x32_bf16 v[204:207], a[192:195], v[40:43], v[204:207]
    ds_read_b128 v[152:155], v33 offset:24832
    ds_read_b64_tr_b16 a[78:79], v225 offset:28672
    v_mfma_f32_16x16x32_bf16 v[204:207], a[196:199], v[44:47], v[204:207]
    ds_read_b128 v[156:159], v33 offset:26880
    ds_read_b64_tr_b16 a[100:101], v225 offset:40960
    v_mfma_f32_16x16x32_bf16 v[204:207], a[200:203], v[48:51], v[204:207]
    ds_read_b128 v[160:163], v33 offset:28928
    ds_read_b64_tr_b16 a[102:103], v225 offset:45056
    v_mfma_f32_16x16x32_bf16 v[204:207], a[204:207], v[52:55], v[204:207]
    ds_read_b128 v[164:167], v33 offset:30976
    v_cvt_pk_bf16_f32 v216, v200, v201
    v_mfma_f32_16x16x32_bf16 v[204:207], a[208:211], v[56:59], v[204:207]
    buffer_load_dwordx4 v18, s[48:51], s83 offen offset:2048 lds
    v_cvt_pk_bf16_f32 v217, v202, v203
    v_mfma_f32_16x16x32_bf16 v[204:207], a[212:215], v[60:63], v[204:207]
    v_min_u32 v216, -2, v216
    v_add_f32 v228, v200, v201
    v_mfma_f32_16x16x32_bf16 v[204:207], a[216:219], v[64:67], v[204:207]
    v_mul_f32 v229, v200, v200
    v_fmac_f32 v229, v201, v201
    v_mfma_f32_16x16x32_bf16 v[204:207], a[220:223], v[68:71], v[204:207]
    v_add_f32 v228, v228, v202
    v_fmac_f32 v229, v202, v202
    v_mfma_f32_16x16x32_bf16 v[204:207], a[224:227], v[72:75], v[204:207]
    buffer_load_dwordx4 v19, s[48:51], s83 offen offset:3072 lds
    v_add_f32 v228, v228, v203
    v_mfma_f32_16x16x32_bf16 v[204:207], a[228:231], v[76:79], v[204:207]
    ds_read_b64_tr_b16 a[108:109], v225 offset:57344
    v_fmac_f32 v229, v203, v203
    v_mfma_f32_16x16x32_bf16 v[204:207], a[232:235], v[80:83], v[204:207]
    ds_read_b64_tr_b16 a[110:111], v225 offset:61440
    v_mfma_f32_16x16x32_bf16 v[204:207], a[236:239], v[84:87], v[204:207]
    v_mfma_f32_16x16x32_bf16 v[204:207], a[240:243], v[88:91], v[204:207]
    v_mfma_f32_16x16x32_bf16 v[204:207], a[244:247], v[92:95], v[204:207]
    v_mfma_f32_16x16x32_bf16 v[204:207], a[248:251], v[96:99], v[204:207]
    v_mfma_f32_16x16x32_bf16 v[204:207], a[252:255], v[100:103], v[204:207]
    s_waitcnt lgkmcnt(15)
    v_mfma_f32_16x16x32_bf16 v[208:211], a[128:131], v[104:107], v[208:211]
    v_mfma_f32_16x16x32_bf16 v[208:211], a[132:135], v[108:111], v[208:211]
    v_mfma_f32_16x16x32_bf16 v[208:211], a[136:139], v[112:115], v[208:211]
    v_mfma_f32_16x16x32_bf16 v[208:211], a[140:143], v[116:119], v[208:211]
    s_nop 2
    v_cvt_pk_bf16_f32 v218, v204, v205
    v_cvt_pk_bf16_f32 v219, v206, v207
    v_mfma_f32_16x16x32_bf16 v[208:211], a[144:147], v[120:123], v[208:211]
    v_min_u32 v218, -2, v218
    v_mfma_f32_16x16x32_bf16 v[208:211], a[148:151], v[124:127], v[208:211]
    buffer_store_dwordx4 v[216:219], v1, s[60:63], s64 offen sc1
    v_add_f32 v228, v228, v204
    v_mfma_f32_16x16x32_bf16 v[208:211], a[152:155], v[128:131], v[208:211]
    v_fmac_f32 v229, v204, v204
    v_add_f32 v228, v228, v205
    v_mfma_f32_16x16x32_bf16 v[208:211], a[156:159], v[132:135], v[208:211]
    s_waitcnt lgkmcnt(13)
    v_fmac_f32 v229, v205, v205
    v_add_f32 v228, v228, v206
    v_mfma_f32_16x16x32_bf16 v[208:211], a[160:163], v[136:139], v[208:211]
    s_waitcnt vmcnt(17) lgkmcnt(0)
    s_barrier
    s_add_u32 m0, s89, 8192
    v_mfma_f32_16x16x32_bf16 v[208:211], a[164:167], v[140:143], v[208:211]
    s_add_u32 s83, s88, 1032192
    buffer_load_dwordx4 v16, s[48:51], s83 offen offset:0 lds
    v_fmac_f32 v229, v206, v206
    v_mfma_f32_16x16x32_bf16 v[208:211], a[168:171], v[144:147], v[208:211]
    v_add_f32 v228, v228, v207
    v_fmac_f32 v229, v207, v207
    v_mfma_f32_16x16x32_bf16 v[208:211], a[172:175], v[148:151], v[208:211]
    ds_read_b64_tr_b16 a[16:17], v226 offset:0
    ds_read_b64_tr_b16 a[18:19], v226 offset:4096
    v_mfma_f32_16x16x32_bf16 v[208:211], a[176:179], v[152:155], v[208:211]
    buffer_load_dwordx4 v17, s[48:51], s83 offen offset:1024 lds
    ds_read_b64_tr_b16 a[24:25], v226 offset:16384
    v_mfma_f32_16x16x32_bf16 v[208:211], a[180:183], v[156:159], v[208:211]
    ds_read_b64_tr_b16 a[26:27], v226 offset:20480
    ds_read_b64_tr_b16 a[48:49], v226 offset:32768
    v_mfma_f32_16x16x32_bf16 v[208:211], a[184:187], v[160:163], v[208:211]
    ds_read_b64_tr_b16 a[50:51], v226 offset:36864
    ds_read_b64_tr_b16 a[56:57], v226 offset:49152
    v_mfma_f32_16x16x32_bf16 v[208:211], a[188:191], v[164:167], v[208:211]
    ds_read_b64_tr_b16 a[58:59], v226 offset:53248
    ds_read_b64_tr_b16 a[80:81], v227 offset:0
    v_mfma_f32_16x16x32_bf16 v[212:215], a[192:195], v[104:107], v[212:215]
    ds_read_b64_tr_b16 a[82:83], v227 offset:4096
    ds_read_b64_tr_b16 a[88:89], v227 offset:16384
    v_mfma_f32_16x16x32_bf16 v[212:215], a[196:199], v[108:111], v[212:215]
    buffer_load_dwordx4 v18, s[48:51], s83 offen offset:2048 lds
    ds_read_b64_tr_b16 a[90:91], v227 offset:20480
    v_mfma_f32_16x16x32_bf16 v[212:215], a[200:203], v[112:115], v[212:215]
    ds_read_b64_tr_b16 a[112:113], v227 offset:32768
    ds_read_b64_tr_b16 a[114:115], v227 offset:36864
    v_mfma_f32_16x16x32_bf16 v[212:215], a[204:207], v[116:119], v[212:215]
    v_cvt_pk_bf16_f32 v220, v208, v209
    v_cvt_pk_bf16_f32 v221, v210, v211
    v_mfma_f32_16x16x32_bf16 v[212:215], a[208:211], v[120:123], v[212:215]
    v_min_u32 v220, -2, v220
    v_add_f32 v230, v208, v209
    v_mfma_f32_16x16x32_bf16 v[212:215], a[212:215], v[124:127], v[212:215]
    buffer_load_dwordx4 v19, s[48:51], s83 offen offset:3072 lds
    v_mul_f32 v231, v208, v208
    v_mfma_f32_16x16x32_bf16 v[212:215], a[216:219], v[128:131], v[212:215]
    v_fmac_f32 v231, v209, v209
    v_add_f32 v230, v230, v210
    v_mfma_f32_16x16x32_bf16 v[212:215], a[220:223], v[132:135], v[212:215]
    v_fmac_f32 v231, v210, v210
    v_add_f32 v230, v230, v211
    v_mfma_f32_16x16x32_bf16 v[212:215], a[224:227], v[136:139], v[212:215]
    ds_read_b64_tr_b16 a[120:121], v227 offset:49152
    v_fmac_f32 v231, v211, v211
    v_mfma_f32_16x16x32_bf16 v[212:215], a[228:231], v[140:143], v[212:215]
    ds_read_b64_tr_b16 a[122:123], v227 offset:53248
    v_mfma_f32_16x16x32_bf16 v[212:215], a[232:235], v[144:147], v[212:215]
    s_add_u32 m0, s89, 12288
    s_add_u32 s83, s88, 1089536
    buffer_load_dwordx4 v16, s[48:51], s83 offen offset:0 lds
    v_mfma_f32_16x16x32_bf16 v[212:215], a[236:239], v[148:151], v[212:215]
    v_mfma_f32_16x16x32_bf16 v[212:215], a[240:243], v[152:155], v[212:215]
    v_mfma_f32_16x16x32_bf16 v[212:215], a[244:247], v[156:159], v[212:215]
    v_mfma_f32_16x16x32_bf16 v[212:215], a[248:251], v[160:163], v[212:215]
    buffer_load_dwordx4 v17, s[48:51], s83 offen offset:1024 lds
    v_mfma_f32_16x16x32_bf16 v[212:215], a[252:255], v[164:167], v[212:215]
    s_nop 7
    v_cvt_pk_bf16_f32 v222, v212, v213
    v_cvt_pk_bf16_f32 v223, v214, v215
    v_min_u32 v222, -2, v222
    buffer_store_dwordx4 v[220:223], v1, s[60:63], s66 offen sc1
    v_add_f32 v230, v230, v212
    v_fmac_f32 v231, v212, v212
    v_add_f32 v230, v230, v213
    v_fmac_f32 v231, v213, v213
    v_add_f32 v230, v230, v214
    v_fmac_f32 v231, v214, v214
    v_add_f32 v230, v230, v215
    v_fmac_f32 v231, v215, v215
    s_nop 0
    v_permlane32_swap_b32 v228, v230
    v_permlane32_swap_b32 v229, v231
    v_add_f32 v228, v228, v230
    v_add_f32 v229, v229, v231
    s_nop 1
    v_permlane16_swap_b32 v228, v229
    v_add_f32 v228, v228, v229
    v_min_u32 v228, -2, v228
    buffer_store_dword v228, v28, s[60:63], s65 offen sc1
    v_mfma_f32_16x16x32_bf16 v[120:123], a[0:3], v[236:239], 0
    s_waitcnt vmcnt(17) lgkmcnt(0)
    s_barrier
    s_lshl_b32 s73, s86, 17
    s_add_u32 s73, s73, s85
    s_add_u32 s73, s73, 2097152
    s_lshl_b32 s74, s86, 14
    s_add_u32 s74, s74, s85
    s_add_u32 s74, s74, 11534336
    s_and_b32 s70, s69, 1
    s_lshl1_add_u32 s70, s68, s70
    ds_read_b64_tr_b16 a[20:21], v226 offset:8192
    ds_read_b64_tr_b16 a[22:23], v226 offset:12288
    ds_read_b64_tr_b16 a[28:29], v226 offset:24576
    ds_read_b64_tr_b16 a[30:31], v226 offset:28672
    buffer_load_dwordx4 v18, s[48:51], s83 offen offset:2048 lds
    v_mfma_f32_16x16x32_bf16 v[120:123], a[4:7], v[236:239], v[120:123]
    s_lshr_b32 s71, s69, 2
    s_bfe_u32 s72, s69, 0x10001
    s_xor_b32 s71, s71, 4
    s_mul_i32 s75, s86, 448
    s_lshl2_add_u32 s76, s87, s3
    s_add_u32 s75, s75, s76
    s_lshl_b32 s75, s75, 10
    s_add_u32 s75, s75, 4194304
    s_lshl_b32 s77, s86, 9
    s_lshl2_add_u32 s77, s76, s77
    ds_read_b64_tr_b16 a[52:53], v226 offset:40960
    ds_read_b64_tr_b16 a[54:55], v226 offset:45056
    ds_read_b64_tr_b16 a[60:61], v226 offset:57344
    ds_read_b64_tr_b16 a[62:63], v226 offset:61440
    buffer_load_dwordx4 v19, s[48:51], s83 offen offset:3072 lds
    v_mfma_f32_16x16x32_bf16 v[120:123], a[8:11], v[236:239], v[120:123]
Lpad_ec03:
Lpad_4:
    s_cbranch_execz Lpad_retc0
    s_add_u32 m0, s89, 65536
    s_add_u32 s83, s88, 1376256
    s_add_u32 s77, s77, 11839488
    s_mov_b64 s[40:41], s[60:61]
    s_cmp_ge_u32 s69, 28
    s_cselect_b32 s42, 0, 13631488
    ds_read_b64_tr_b16 a[84:85], v227 offset:8192
    ds_read_b64_tr_b16 a[86:87], v227 offset:12288
    ds_read_b64_tr_b16 a[92:93], v227 offset:24576
    ds_read_b64_tr_b16 a[94:95], v227 offset:28672
    buffer_load_dwordx4 v16, s[48:51], s83 offen offset:0 lds
    v_mfma_f32_16x16x32_bf16 v[120:123], a[12:15], v[236:239], v[120:123]
    ds_read_b64_tr_b16 a[116:117], v227 offset:40960
    ds_read_b64_tr_b16 a[118:119], v227 offset:45056
    ds_read_b64_tr_b16 a[124:125], v227 offset:57344
    ds_read_b64_tr_b16 a[126:127], v227 offset:61440
    v_mfma_f32_16x16x32_bf16 v[124:127], a[32:35], v[236:239], 0
    buffer_load_dwordx4 v17, s[48:51], s83 offen offset:1024 lds
    v_mfma_f32_16x16x32_bf16 v[124:127], a[36:39], v[236:239], v[124:127]
    buffer_load_dwordx4 v18, s[48:51], s83 offen offset:2048 lds
    v_mfma_f32_16x16x32_bf16 v[124:127], a[40:43], v[236:239], v[124:127]
    buffer_load_dwordx4 v19, s[48:51], s83 offen offset:3072 lds
    v_mfma_f32_16x16x32_bf16 v[124:127], a[44:47], v[236:239], v[124:127]
    v_mfma_f32_16x16x32_bf16 v[128:131], a[64:67], v[236:239], 0
    s_add_u32 m0, s89, 69632
    s_add_u32 s83, s88, 1433600
    s_lshl_b32 s79, s70, 9
    s_add_u32 s79, s79, 11839488
    s_lshl3_add_u32 s87, s70, s72
    s_mul_i32 s82, s87, 56
    s_mul_i32 s76, s3, 14
    s_add_u32 s82, s82, s76
    s_lshl_b32 s82, s82, 10
    s_add_u32 s82, s82, 4194304
    s_lshl_b32 s78, s87, 14
    s_lshl_b32 s86, s71, 11
    s_add_u32 s86, s86, s78
    s_lshl_b32 s72, s3, 2
    buffer_load_dwordx4 v16, s[48:51], s83 offen offset:0 lds
    v_mfma_f32_16x16x32_bf16 v[128:131], a[68:71], v[236:239], v[128:131]
    s_lshl4_add_u32 s86, s72, s86
    s_add_u32 s86, s86, 2097152
    s_lshl_b32 s87, s71, 7
    s_add_u32 s78, s78, s87
    s_mul_i32 s47, s3, 458752
    s_add_u32 s47, s47, s87
    s_add_u32 s78, s78, s85
    s_mul_i32 s66, s3, 448
    s_add_u32 s66, s66, s86
    s_bitcmp0_b32 s3, 0
    s_cselect_b32 s65, 504, 0
    s_add_u32 s66, s66, s65
    s_add_u32 s66, s66, 97800
    s_mul_i32 s65, s3, 4064
    s_sub_u32 s65, s78, s65
    buffer_load_dwordx4 v17, s[48:51], s83 offen offset:1024 lds
    v_mfma_f32_16x16x32_bf16 v[128:131], a[72:75], v[236:239], v[128:131]
    s_add_u32 s65, s65, 98304
    buffer_load_dwordx4 v18, s[48:51], s83 offen offset:2048 lds
    v_lshrrev_b32 v244, 2, v0
    v_bfe_u32 v245, v0, 3, 2
    v_xor_b32 v245, s3, v245
    v_lshlrev_b32 v244, 7, v244
    v_lshl_add_u32 v244, v245, 5, v244
    v_and_b32 v245, 3, v0
    v_lshl_add_u32 v244, v245, 3, v244
    v_add_u32 v244, s85, v244
    v_xor_b32 v4, 0, v244
    v_add_u32 v5, 65536, v4
    v_add_u32 v6, 131072, v4
    v_xor_b32 v7, 32, v244
    v_add_u32 v8, 65536, v7
    v_mfma_f32_16x16x32_bf16 v[128:131], a[76:79], v[236:239], v[128:131]
    v_add_u32 v9, 131072, v7
    v_xor_b32 v10, 64, v244
    v_add_u32 v11, 65536, v10
    v_add_u32 v12, 131072, v10
    v_xor_b32 v13, 96, v244
    v_add_u32 v14, 65536, v13
    v_add_u32 v15, 131072, v13
    v_mfma_f32_16x16x32_bf16 v[132:135], a[96:99], v[236:239], 0
    buffer_load_dwordx4 v19, s[48:51], s83 offen offset:3072 lds
    v_mfma_f32_16x16x32_bf16 v[132:135], a[100:103], v[236:239], v[132:135]
    s_add_u32 m0, s85, 131072
    s_add_u32 s83, s73, 0
    buffer_load_dwordx4 v1, s[60:63], s83 offen offset:0 sc1 lds
    v_mfma_f32_16x16x32_bf16 v[132:135], a[104:107], v[236:239], v[132:135]
    s_waitcnt vmcnt(20) lgkmcnt(0)
    s_barrier
    ds_read_b64_tr_b16 a[128:129], v224 offset:0
    ds_read_b64_tr_b16 a[130:131], v224 offset:4096
    ds_read_b64_tr_b16 a[136:137], v224 offset:16384
    ds_read_b64_tr_b16 a[138:139], v224 offset:20480
    buffer_load_dwordx4 v1, s[60:63], s83 offen offset:1024 sc1 lds
    v_mfma_f32_16x16x32_bf16 v[132:135], a[108:111], v[236:239], v[132:135]
    ds_read_b64_tr_b16 a[160:161], v224 offset:32768
    ds_read_b64_tr_b16 a[162:163], v224 offset:36864
    ds_read_b64_tr_b16 a[168:169], v224 offset:49152
    ds_read_b64_tr_b16 a[170:171], v224 offset:53248
    v_mfma_f32_16x16x32_bf16 v[120:123], a[16:19], v[236:239], v[120:123]
    ds_read_b64_tr_b16 a[192:193], v225 offset:0
    ds_read_b64_tr_b16 a[194:195], v225 offset:4096
    ds_read_b64_tr_b16 a[200:201], v225 offset:16384
    ds_read_b64_tr_b16 a[202:203], v225 offset:20480
    buffer_load_dwordx4 v1, s[60:63], s83 offen offset:2048 sc1 lds
    v_mfma_f32_16x16x32_bf16 v[120:123], a[20:23], v[236:239], v[120:123]
    ds_read_b64_tr_b16 a[224:225], v225 offset:32768
    ds_read_b64_tr_b16 a[226:227], v225 offset:36864
    ds_read_b64_tr_b16 a[232:233], v225 offset:49152
    ds_read_b64_tr_b16 a[234:235], v225 offset:53248
    buffer_load_dwordx4 v1, s[60:63], s83 offen offset:3072 sc1 lds
    v_mfma_f32_16x16x32_bf16 v[120:123], a[24:27], v[236:239], v[120:123]
    s_add_u32 m0, s89, 73728
    s_add_u32 s83, s88, 1490944
    buffer_load_dwordx4 v16, s[48:51], s83 offen offset:0 lds
    v_mfma_f32_16x16x32_bf16 v[120:123], a[28:31], v[236:239], v[120:123]
    v_mfma_f32_16x16x32_bf16 v[124:127], a[48:51], v[236:239], v[124:127]
    buffer_load_dwordx4 v17, s[48:51], s83 offen offset:1024 lds
    v_mfma_f32_16x16x32_bf16 v[124:127], a[52:55], v[236:239], v[124:127]
    s_waitcnt lgkmcnt(0)
    buffer_load_dwordx4 v18, s[48:51], s83 offen offset:2048 lds
    v_mfma_f32_16x16x32_bf16 v[124:127], a[56:59], v[236:239], v[124:127]
    buffer_load_dwordx4 v19, s[48:51], s83 offen offset:3072 lds
    v_mfma_f32_16x16x32_bf16 v[120:123], a[128:131], v[236:239], v[120:123]
    v_mfma_f32_16x16x32_bf16 v[124:127], a[60:63], v[236:239], v[124:127]
    v_mfma_f32_16x16x32_bf16 v[120:123], a[136:139], v[236:239], v[120:123]
    v_mfma_f32_16x16x32_bf16 v[128:131], a[80:83], v[236:239], v[128:131]
    s_add_u32 m0, s89, 77824
    s_add_u32 s83, s88, 1548288
    buffer_load_dwordx4 v16, s[48:51], s83 offen offset:0 lds
    v_mfma_f32_16x16x32_bf16 v[124:127], a[160:163], v[236:239], v[124:127]
    v_mfma_f32_16x16x32_bf16 v[128:131], a[84:87], v[236:239], v[128:131]
    buffer_load_dwordx4 v17, s[48:51], s83 offen offset:1024 lds
    v_mfma_f32_16x16x32_bf16 v[124:127], a[168:171], v[236:239], v[124:127]
    v_mfma_f32_16x16x32_bf16 v[128:131], a[88:91], v[236:239], v[128:131]
    s_waitcnt vmcnt(18)
    s_barrier
    ds_read_b64_tr_b16 a[132:133], v224 offset:8192
    ds_read_b64_tr_b16 a[134:135], v224 offset:12288
    ds_read_b64_tr_b16 a[140:141], v224 offset:24576
    ds_read_b64_tr_b16 a[142:143], v224 offset:28672
    buffer_load_dwordx4 v18, s[48:51], s83 offen offset:2048 lds
    v_mfma_f32_16x16x32_bf16 v[128:131], a[192:195], v[236:239], v[128:131]
    v_mfma_f32_16x16x32_bf16 v[128:131], a[92:95], v[236:239], v[128:131]
    ds_read_b64_tr_b16 a[164:165], v224 offset:40960
    ds_read_b64_tr_b16 a[166:167], v224 offset:45056
    ds_read_b64_tr_b16 a[172:173], v224 offset:57344
    ds_read_b64_tr_b16 a[174:175], v224 offset:61440
    v_mfma_f32_16x16x32_bf16 v[128:131], a[200:203], v[236:239], v[128:131]
    v_mfma_f32_16x16x32_bf16 v[132:135], a[112:115], v[236:239], v[132:135]
    ds_read_b64_tr_b16 a[196:197], v225 offset:8192
    ds_read_b64_tr_b16 a[198:199], v225 offset:12288
    ds_read_b64_tr_b16 a[204:205], v225 offset:24576
    ds_read_b64_tr_b16 a[206:207], v225 offset:28672
    buffer_load_dwordx4 v19, s[48:51], s83 offen offset:3072 lds
    v_mfma_f32_16x16x32_bf16 v[132:135], a[224:227], v[236:239], v[132:135]
    v_mfma_f32_16x16x32_bf16 v[132:135], a[116:119], v[236:239], v[132:135]
    ds_read_b64_tr_b16 a[228:229], v225 offset:40960
    ds_read_b64_tr_b16 a[230:231], v225 offset:45056
    ds_read_b64_tr_b16 a[236:237], v225 offset:57344
    ds_read_b64_tr_b16 a[238:239], v225 offset:61440
    buffer_load_dwordx4 v[160:163], v1, s[60:63], s74 offen offset:0 sc1
    v_mfma_f32_16x16x32_bf16 v[132:135], a[232:235], v[236:239], v[132:135]
    v_mfma_f32_16x16x32_bf16 v[132:135], a[120:123], v[236:239], v[132:135]
    s_waitcnt vmcnt(9)
    buffer_load_dwordx4 v[164:167], v1, s[60:63], s74 offen offset:1024 sc1
    ds_read2st64_b32 v[30:31], v3 offset0:0 offset1:4
    ds_read2st64_b32 v[32:33], v3 offset0:8 offset1:12
    v_mfma_f32_16x16x32_bf16 v[132:135], a[124:127], v[236:239], v[132:135]
    s_cmp_ge_u32 s69, 28
    s_cbranch_scc1 LC_idle
    s_waitcnt lgkmcnt(0)
    v_mfma_f32_16x16x32_bf16 v[120:123], a[132:135], v[236:239], v[120:123]
    v_max3_u32 v30, v30, v31, v32
    v_max_u32 v30, v30, v33
    v_cmp_eq_u32 vcc, -1, v30
    v_mfma_f32_16x16x32_bf16 v[120:123], a[140:143], v[236:239], v[120:123]
    v_mfma_f32_16x16x32_bf16 v[124:127], a[164:167], v[236:239], v[124:127]
    s_cbranch_vccnz LX_h0
LR_h0:
    v_subrev_u32 v3, 131072, v3
    s_barrier
    ds_read_b128 v[40:43], v34 offset:0
    ds_read_b128 v[44:47], v34 offset:1024
    v_mfma_f32_16x16x32_bf16 v[124:127], a[172:175], v[236:239], v[124:127]
    ds_read_b128 v[48:51], v34 offset:2048
    ds_read_b128 v[52:55], v34 offset:3072
    v_mfma_f32_16x16x32_bf16 v[128:131], a[196:199], v[236:239], v[128:131]
    ds_read_b128 v[56:59], v34 offset:4096
    ds_read_b128 v[60:63], v34 offset:5120
    v_mfma_f32_16x16x32_bf16 v[128:131], a[204:207], v[236:239], v[128:131]
    ds_read_b128 v[64:67], v34 offset:6144
    ds_read_b128 v[68:71], v34 offset:7168
    v_mfma_f32_16x16x32_bf16 v[132:135], a[228:231], v[236:239], v[132:135]
    buffer_load_dwordx4 v[168:171], v1, s[60:63], s74 offen offset:2048 sc1
    v_mfma_f32_16x16x32_bf16 v[132:135], a[236:239], v[236:239], v[132:135]
    s_waitcnt lgkmcnt(4)
    v_mfma_f32_16x16x32_bf16 v[104:107], a[0:3], v[40:43], 0
    ds_read_b128 v[72:75], v34 offset:8192
    ds_read_b128 v[76:79], v34 offset:9216
    v_mfma_f32_16x16x32_bf16 v[104:107], a[4:7], v[44:47], v[104:107]
    ds_read_b128 v[80:83], v34 offset:10240
    ds_read_b128 v[84:87], v34 offset:11264
    v_mfma_f32_16x16x32_bf16 v[104:107], a[8:11], v[48:51], v[104:107]
    buffer_load_dwordx4 v[172:175], v1, s[60:63], s74 offen offset:3072 sc1
    ds_read_b128 v[88:91], v34 offset:12288
    v_mfma_f32_16x16x32_bf16 v[104:107], a[12:15], v[52:55], v[104:107]
    s_waitcnt lgkmcnt(5)
    ds_read_b128 v[92:95], v34 offset:13312
    ds_read_b128 v[96:99], v34 offset:14336
    v_mfma_f32_16x16x32_bf16 v[104:107], a[16:19], v[56:59], v[104:107]
    s_add_u32 m0, s85, 16384
    ds_read_b128 v[100:103], v34 offset:15360
    v_mfma_f32_16x16x32_bf16 v[104:107], a[20:23], v[60:63], v[104:107]
    s_add_u32 s83, s73, 16384
    buffer_load_dwordx4 v1, s[60:63], s83 offen offset:0 sc1 lds
    v_mfma_f32_16x16x32_bf16 v[104:107], a[24:27], v[64:67], v[104:107]
    v_mfma_f32_16x16x32_bf16 v[104:107], a[28:31], v[68:71], v[104:107]
    s_waitcnt lgkmcnt(4)
    v_mfma_f32_16x16x32_bf16 v[104:107], a[128:131], v[72:75], v[104:107]
    s_lshl_b32 s76, s3, 9
    s_add_u32 s76, s76, 147456
    buffer_load_dwordx4 v1, s[60:63], s83 offen offset:1024 sc1 lds
    v_mfma_f32_16x16x32_bf16 v[104:107], a[132:135], v[76:79], v[104:107]
    v_lshrrev_b32 v242, 5, v0
    v_and_b32 v243, 15, v0
    v_mfma_f32_16x16x32_bf16 v[104:107], a[136:139], v[80:83], v[104:107]
    v_lshl_add_u32 v242, v243, 1, v242
    v_lshl_add_u32 v242, v242, 4, s76
    v_mfma_f32_16x16x32_bf16 v[104:107], a[140:143], v[84:87], v[104:107]
    buffer_load_dwordx4 v1, s[60:63], s83 offen offset:2048 sc1 lds
    v_mfma_f32_16x16x32_bf16 v[108:111], a[32:35], v[40:43], 0
    v_mfma_f32_16x16x32_bf16 v[108:111], a[36:39], v[44:47], v[108:111]
    v_mfma_f32_16x16x32_bf16 v[108:111], a[40:43], v[48:51], v[108:111]
    buffer_load_dwordx4 v1, s[60:63], s83 offen offset:3072 sc1 lds
    v_mfma_f32_16x16x32_bf16 v[108:111], a[44:47], v[52:55], v[108:111]
    v_mfma_f32_16x16x32_bf16 v[108:111], a[48:51], v[56:59], v[108:111]
    v_mfma_f32_16x16x32_bf16 v[108:111], a[52:55], v[60:63], v[108:111]
    v_mfma_f32_16x16x32_bf16 v[108:111], a[56:59], v[64:67], v[108:111]
    v_mfma_f32_16x16x32_bf16 v[108:111], a[60:63], v[68:71], v[108:111]
    v_mfma_f32_16x16x32_bf16 v[108:111], a[160:163], v[72:75], v[108:111]
    s_waitcnt vmcnt(8) lgkmcnt(0)
    s_barrier
    v_mfma_f32_16x16x32_bf16 v[108:111], a[164:167], v[76:79], v[108:111]
    s_add_u32 s83, s75, 229376
    ds_read_b64_tr_b16 a[144:145], v226 offset:0
    ds_read_b64_tr_b16 a[146:147], v226 offset:4096
    v_mfma_f32_16x16x32_bf16 v[108:111], a[168:171], v[80:83], v[108:111]
    ds_read_b64_tr_b16 a[152:153], v226 offset:16384
    ds_read_b64_tr_b16 a[154:155], v226 offset:20480
    v_mfma_f32_16x16x32_bf16 v[108:111], a[172:175], v[84:87], v[108:111]
    ds_read_b64_tr_b16 a[148:149], v226 offset:8192
    ds_read_b64_tr_b16 a[150:151], v226 offset:12288
    v_mfma_f32_16x16x32_bf16 v[112:115], a[64:67], v[40:43], 0
    buffer_store_dwordx4 v[252:255], v1, s[40:43], s83 offen sc1
    ds_read_b64_tr_b16 a[156:157], v226 offset:24576
    v_mfma_f32_16x16x32_bf16 v[112:115], a[68:71], v[44:47], v[112:115]
    ds_read_b64_tr_b16 a[158:159], v226 offset:28672
    ds_read_b64_tr_b16 a[176:177], v226 offset:32768
    v_mfma_f32_16x16x32_bf16 v[112:115], a[72:75], v[48:51], v[112:115]
    ds_read_b64_tr_b16 a[178:179], v226 offset:36864
    ds_read_b64_tr_b16 a[184:185], v226 offset:49152
    v_mfma_f32_16x16x32_bf16 v[112:115], a[76:79], v[52:55], v[112:115]
    s_add_u32 s83, s75, 286720
    ds_read_b64_tr_b16 a[186:187], v226 offset:53248
    ds_read_b64_tr_b16 a[180:181], v226 offset:40960
    v_mfma_f32_16x16x32_bf16 v[112:115], a[80:83], v[56:59], v[112:115]
    ds_read_b64_tr_b16 a[182:183], v226 offset:45056
    ds_read_b64_tr_b16 a[188:189], v226 offset:57344
    v_mfma_f32_16x16x32_bf16 v[112:115], a[84:87], v[60:63], v[112:115]
    ds_read_b64_tr_b16 a[190:191], v226 offset:61440
    ds_read_b64_tr_b16 a[208:209], v227 offset:0
    v_mfma_f32_16x16x32_bf16 v[112:115], a[88:91], v[64:67], v[112:115]
    buffer_store_dwordx4 v[252:255], v1, s[40:43], s83 offen sc1
    ds_read_b64_tr_b16 a[210:211], v227 offset:4096
    v_mfma_f32_16x16x32_bf16 v[112:115], a[92:95], v[68:71], v[112:115]
    ds_read_b64_tr_b16 a[216:217], v227 offset:16384
    ds_read_b64_tr_b16 a[218:219], v227 offset:20480
    v_mfma_f32_16x16x32_bf16 v[112:115], a[192:195], v[72:75], v[112:115]
    ds_read_b64_tr_b16 a[212:213], v227 offset:8192
    ds_read_b64_tr_b16 a[214:215], v227 offset:12288
    v_mfma_f32_16x16x32_bf16 v[112:115], a[196:199], v[76:79], v[112:115]
    s_add_u32 s83, s75, 344064
    ds_read_b64_tr_b16 a[220:221], v227 offset:24576
    ds_read_b64_tr_b16 a[222:223], v227 offset:28672
    v_mfma_f32_16x16x32_bf16 v[112:115], a[200:203], v[80:83], v[112:115]
    s_waitcnt vmcnt(6)
    v_add_f32 v160, v160, v168
    v_add_f32 v161, v161, v169
    v_mfma_f32_16x16x32_bf16 v[112:115], a[204:207], v[84:87], v[112:115]
    v_add_f32 v162, v162, v170
    v_add_f32 v163, v163, v171
    v_mfma_f32_16x16x32_bf16 v[116:119], a[96:99], v[40:43], 0
    buffer_store_dwordx4 v[252:255], v1, s[40:43], s83 offen sc1
    v_add_f32 v164, v164, v172
    v_mfma_f32_16x16x32_bf16 v[116:119], a[100:103], v[44:47], v[116:119]
    v_add_f32 v165, v165, v173
    v_add_f32 v166, v166, v174
    v_mfma_f32_16x16x32_bf16 v[116:119], a[104:107], v[48:51], v[116:119]
    v_add_f32 v167, v167, v175
    v_add_f32 v160, v160, v164
    v_mfma_f32_16x16x32_bf16 v[116:119], a[108:111], v[52:55], v[116:119]
    s_add_u32 s83, s75, 401408
    v_add_f32 v161, v161, v165
    v_add_f32 v162, v162, v166
    v_mfma_f32_16x16x32_bf16 v[116:119], a[112:115], v[56:59], v[116:119]
    v_add_f32 v163, v163, v167
    v_permlane32_swap_b32 v160, v162
    v_mfma_f32_16x16x32_bf16 v[116:119], a[116:119], v[60:63], v[116:119]
    v_permlane32_swap_b32 v161, v163
    v_add_f32 v160, v160, v162
    v_mfma_f32_16x16x32_bf16 v[116:119], a[120:123], v[64:67], v[116:119]
    buffer_store_dwordx4 v[252:255], v1, s[40:43], s83 offen sc1
    v_add_f32 v161, v161, v163
    v_mfma_f32_16x16x32_bf16 v[116:119], a[124:127], v[68:71], v[116:119]
    v_mov_b32 v162, v160
    v_mov_b32 v163, v161
    v_mfma_f32_16x16x32_bf16 v[116:119], a[224:227], v[72:75], v[116:119]
    v_cmp_u_f32 vcc, v160, v161
    v_permlane16_swap_b32 v160, v162
    v_mfma_f32_16x16x32_bf16 v[116:119], a[228:231], v[76:79], v[116:119]
    v_permlane16_swap_b32 v161, v163
    v_add_f32 v160, v160, v162
    v_mfma_f32_16x16x32_bf16 v[116:119], a[232:235], v[80:83], v[116:119]
    ds_read_b64_tr_b16 a[240:241], v227 offset:32768
    v_add_f32 v161, v161, v163
    v_mfma_f32_16x16x32_bf16 v[116:119], a[236:239], v[84:87], v[116:119]
    s_waitcnt lgkmcnt(15)
    s_cbranch_vccnz LX_st
LR_st:
    v_mfma_f32_16x16x32_bf16 v[104:107], a[144:147], v[88:91], v[104:107]
    v_mul_f32 v164, 0xbb000000, v160
    v_mul_f32 v161, 0x3b000000, v161
    v_mfma_f32_16x16x32_bf16 v[104:107], a[148:151], v[92:95], v[104:107]
    v_fma_f32 v161, -v164, v164, v161
    v_max_f32 v161, 0, v161
    v_mfma_f32_16x16x32_bf16 v[104:107], a[152:155], v[96:99], v[104:107]
    ds_read_b64_tr_b16 a[242:243], v227 offset:36864
    v_add_f32 v167, 0x3727c5ac, v161
    v_mfma_f32_16x16x32_bf16 v[104:107], a[156:159], v[100:103], v[104:107]
    v_rsq_f32 v160, v167
    v_mfma_f32_16x16x32_bf16 v[120:123], a[144:147], v[236:239], v[120:123]
    v_mul_f32 v161, v160, v160
    v_mul_f32 v165, 0xc0135761, v160
    v_mfma_f32_16x16x32_bf16 v[120:123], a[148:151], v[236:239], v[120:123]
    s_add_u32 m0, s85, 32768
    v_mul_f32 v161, 0x3d372713, v161
    v_mul_f32 v166, v165, v161
    v_mfma_f32_16x16x32_bf16 v[120:123], a[152:155], v[236:239], v[120:123]
    s_add_u32 s83, s73, 32768
    ds_write_b128 v242, v[164:167]
    v_mfma_f32_16x16x32_bf16 v[120:123], a[156:159], v[236:239], v[120:123]
    s_waitcnt lgkmcnt(11)
    ds_read_b64_tr_b16 a[248:249], v227 offset:49152
    ds_read_b64_tr_b16 a[250:251], v227 offset:53248
    v_mfma_f32_16x16x32_bf16 v[108:111], a[176:179], v[88:91], v[108:111]
    buffer_load_dwordx4 v1, s[60:63], s83 offen offset:0 sc1 lds
    ds_read_b64_tr_b16 a[244:245], v227 offset:40960
    v_mfma_f32_16x16x32_bf16 v[108:111], a[180:183], v[92:95], v[108:111]
    ds_read_b64_tr_b16 a[246:247], v227 offset:45056
    ds_read_b64_tr_b16 a[252:253], v227 offset:57344
    v_mfma_f32_16x16x32_bf16 v[108:111], a[184:187], v[96:99], v[108:111]
    ds_read_b64_tr_b16 a[254:255], v227 offset:61440
    v_mfma_f32_16x16x32_bf16 v[108:111], a[188:191], v[100:103], v[108:111]
    v_mfma_f32_16x16x32_bf16 v[124:127], a[176:179], v[236:239], v[124:127]
    s_waitcnt vmcnt(5)
    ds_read2st64_b32 v[30:31], v3 offset0:64 offset1:68
    ds_read2st64_b32 v[32:33], v3 offset0:72 offset1:76
    v_mfma_f32_16x16x32_bf16 v[124:127], a[180:183], v[236:239], v[124:127]
    buffer_load_dwordx4 v1, s[60:63], s83 offen offset:1024 sc1 lds
    v_mfma_f32_16x16x32_bf16 v[124:127], a[184:187], v[236:239], v[124:127]
    v_mfma_f32_16x16x32_bf16 v[124:127], a[188:191], v[236:239], v[124:127]
    s_waitcnt lgkmcnt(11)
    v_mfma_f32_16x16x32_bf16 v[112:115], a[208:211], v[88:91], v[112:115]
    buffer_load_dwordx4 v1, s[60:63], s83 offen offset:2048 sc1 lds
    v_mfma_f32_16x16x32_bf16 v[112:115], a[212:215], v[92:95], v[112:115]
    v_mfma_f32_16x16x32_bf16 v[112:115], a[216:219], v[96:99], v[112:115]
    s_waitcnt lgkmcnt(0)
    v_max3_u32 v30, v30, v31, v32
    v_max_u32 v30, v30, v33
    v_mfma_f32_16x16x32_bf16 v[112:115], a[220:223], v[100:103], v[112:115]
    v_cmp_eq_u32 vcc, -1, v30
    v_mfma_f32_16x16x32_bf16 v[128:131], a[208:211], v[236:239], v[128:131]
    buffer_load_dwordx4 v1, s[60:63], s83 offen offset:3072 sc1 lds
    v_mfma_f32_16x16x32_bf16 v[128:131], a[212:215], v[236:239], v[128:131]
    s_cbranch_vccnz LX_h1
LR_h1:
    v_mfma_f32_16x16x32_bf16 v[128:131], a[216:219], v[236:239], v[128:131]
    s_barrier
    ds_read_b128 v[136:139], v22 offset:0
    v_mfma_f32_16x16x32_bf16 v[128:131], a[220:223], v[236:239], v[128:131]
    s_add_u32 m0, s85, 0
    ds_read_b128 v[40:43], v20 offset:16384
    ds_read_b128 v[44:47], v20 offset:17408
    v_mfma_f32_16x16x32_bf16 v[116:119], a[240:243], v[88:91], v[116:119]
    s_add_u32 s83, s47, 0
    ds_read_b128 v[48:51], v20 offset:18432
    ds_read_b128 v[52:55], v20 offset:19456
    v_mfma_f32_16x16x32_bf16 v[116:119], a[244:247], v[92:95], v[116:119]
    ds_read_b128 v[88:91], v20 offset:28672
    buffer_load_dwordx4 v35, s[52:55], s83 offen offset:0 lds
    v_mfma_f32_16x16x32_bf16 v[116:119], a[248:251], v[96:99], v[116:119]
    s_waitcnt lgkmcnt(5)
    v_fma_f32 v144, v136, v120, v104
    v_fma_f32 v145, v136, v121, v105
    v_mfma_f32_16x16x32_bf16 v[116:119], a[252:255], v[100:103], v[116:119]
    ds_read_b128 v[92:95], v20 offset:29696
    v_fma_f32 v146, v136, v122, v106
    v_mfma_f32_16x16x32_bf16 v[132:135], a[240:243], v[236:239], v[132:135]
    ds_read_b128 v[96:99], v20 offset:30720
    buffer_load_dwordx4 v36, s[52:55], s83 offen offset:1024 lds
    v_mfma_f32_16x16x32_bf16 v[132:135], a[244:247], v[236:239], v[132:135]
    ds_read_b128 v[56:59], v20 offset:20480
    v_fma_f32 v147, v136, v123, v107
    v_mfma_f32_16x16x32_bf16 v[132:135], a[248:251], v[236:239], v[132:135]
    ds_read_b128 v[100:103], v20 offset:31744
    ds_read_b128 v[60:63], v20 offset:21504
    ds_read_b128 v[64:67], v20 offset:22528
    ds_read_b128 v[68:71], v20 offset:23552
    v_mfma_f32_16x16x32_bf16 v[132:135], a[252:255], v[236:239], v[132:135]
    s_waitcnt lgkmcnt(8)
    ds_read_b128 v[72:75], v20 offset:24576
    ds_read_b128 v[76:79], v20 offset:25600
    v_mfma_f32_16x16x32_bf16 v[104:107], a[0:3], v[40:43], 0
    s_add_u32 s76, s75, 0
    buffer_load_dwordx4 v37, s[52:55], s83 offen offset:2048 lds
    ds_read_b128 v[80:83], v20 offset:26624
    v_mfma_f32_16x16x32_bf16 v[104:107], a[4:7], v[44:47], v[104:107]
    ds_read_b128 v[84:87], v20 offset:27648
    v_fma_f32 v148, v136, v124, v108
    v_mfma_f32_16x16x32_bf16 v[104:107], a[8:11], v[48:51], v[104:107]
    v_fma_f32 v149, v136, v125, v109
    v_fma_f32 v150, v136, v126, v110
    v_mfma_f32_16x16x32_bf16 v[104:107], a[12:15], v[52:55], v[104:107]
    s_waitcnt lgkmcnt(4)
    ds_read_b128 v[140:143], v22 offset:256
    v_fma_f32 v151, v136, v127, v111
    v_mfma_f32_16x16x32_bf16 v[104:107], a[16:19], v[56:59], v[104:107]
    buffer_load_dwordx4 v38, s[52:55], s83 offen offset:3072 lds
    v_mul_f32 v152, v144, v144
    v_mfma_f32_16x16x32_bf16 v[104:107], a[20:23], v[60:63], v[104:107]
    s_add_u32 m0, s85, 49152
    v_mul_f32 v153, v145, v145
    v_mul_f32 v154, v146, v146
    v_mfma_f32_16x16x32_bf16 v[104:107], a[24:27], v[64:67], v[104:107]
    s_add_u32 s83, s73, 49152
    v_mul_f32 v155, v147, v147
    v_fma_f32 v152, v152, v138, v137
    v_mfma_f32_16x16x32_bf16 v[104:107], a[28:31], v[68:71], v[104:107]
    s_waitcnt lgkmcnt(1)
    v_fma_f32 v153, v153, v138, v137
    v_fma_f32 v154, v154, v138, v137
    v_mfma_f32_16x16x32_bf16 v[104:107], a[128:131], v[72:75], v[104:107]
    buffer_load_dwordx4 v1, s[60:63], s83 offen offset:0 sc1 lds
    v_fma_f32 v155, v155, v138, v137
    v_mfma_f32_16x16x32_bf16 v[104:107], a[132:135], v[76:79], v[104:107]
    v_mul_f32 v152, v152, v144
    v_mul_f32 v153, v153, v145
    v_mfma_f32_16x16x32_bf16 v[104:107], a[136:139], v[80:83], v[104:107]
    v_mul_f32 v154, v154, v146
    v_mul_f32 v155, v155, v147
    v_mfma_f32_16x16x32_bf16 v[104:107], a[140:143], v[84:87], v[104:107]
    v_exp_f32 v152, v152
    v_mfma_f32_16x16x32_bf16 v[104:107], a[144:147], v[88:91], v[104:107]
    buffer_load_dwordx4 v1, s[60:63], s83 offen offset:1024 sc1 lds
    v_mfma_f32_16x16x32_bf16 v[104:107], a[148:151], v[92:95], v[104:107]
    v_exp_f32 v153, v153
    v_mfma_f32_16x16x32_bf16 v[104:107], a[152:155], v[96:99], v[104:107]
    v_exp_f32 v154, v154
    v_mfma_f32_16x16x32_bf16 v[104:107], a[156:159], v[100:103], v[104:107]
    v_exp_f32 v155, v155
    v_mfma_f32_16x16x32_bf16 v[108:111], a[32:35], v[40:43], 0
    buffer_load_dwordx4 v1, s[60:63], s83 offen offset:2048 sc1 lds
    v_mul_f32 v144, v144, v148
    v_mfma_f32_16x16x32_bf16 v[108:111], a[36:39], v[44:47], v[108:111]
    v_mul_f32 v145, v145, v149
    v_mul_f32 v146, v146, v150
    v_mfma_f32_16x16x32_bf16 v[108:111], a[40:43], v[48:51], v[108:111]
    v_mul_f32 v147, v147, v151
    v_fma_f32 v152, v152, v139, v139
    v_mfma_f32_16x16x32_bf16 v[108:111], a[44:47], v[52:55], v[108:111]
    v_fma_f32 v153, v153, v139, v139
    v_fma_f32 v154, v154, v139, v139
    v_mfma_f32_16x16x32_bf16 v[108:111], a[48:51], v[56:59], v[108:111]
    buffer_load_dwordx4 v1, s[60:63], s83 offen offset:3072 sc1 lds
    v_fma_f32 v155, v155, v139, v139
    v_mfma_f32_16x16x32_bf16 v[108:111], a[52:55], v[60:63], v[108:111]
    s_add_u32 m0, s85, 131072
    v_rcp_f32 v152, v152
    v_mfma_f32_16x16x32_bf16 v[108:111], a[56:59], v[64:67], v[108:111]
    s_add_u32 s83, s47, 32768
    v_rcp_f32 v153, v153
    v_mfma_f32_16x16x32_bf16 v[108:111], a[60:63], v[68:71], v[108:111]
    v_rcp_f32 v154, v154
    v_mfma_f32_16x16x32_bf16 v[108:111], a[160:163], v[72:75], v[108:111]
    buffer_load_dwordx4 v35, s[52:55], s83 offen offset:0 lds
    v_mfma_f32_16x16x32_bf16 v[108:111], a[164:167], v[76:79], v[108:111]
    v_rcp_f32 v155, v155
    v_mfma_f32_16x16x32_bf16 v[108:111], a[168:171], v[80:83], v[108:111]
    v_mul_f32 v144, v144, v152
    v_mul_f32 v145, v145, v153
    v_mfma_f32_16x16x32_bf16 v[108:111], a[172:175], v[84:87], v[108:111]
    v_mul_f32 v146, v146, v154
    v_mul_f32 v147, v147, v155
    v_mfma_f32_16x16x32_bf16 v[108:111], a[176:179], v[88:91], v[108:111]
    v_cvt_pk_bf16_f32 v156, v144, v145
    v_cvt_pk_bf16_f32 v157, v146, v147
    v_mfma_f32_16x16x32_bf16 v[108:111], a[180:183], v[92:95], v[108:111]
    buffer_load_dwordx4 v36, s[52:55], s83 offen offset:1024 lds
    v_pk_fma_f32 v[144:145], v[136:137], v[128:129], v[112:113] op_sel_hi:[0,1,1]
    v_pk_fma_f32 v[146:147], v[136:137], v[130:131], v[114:115] op_sel_hi:[0,1,1]
    v_pk_fma_f32 v[148:149], v[136:137], v[132:133], v[116:117] op_sel_hi:[0,1,1]
    v_pk_fma_f32 v[150:151], v[136:137], v[134:135], v[118:119] op_sel_hi:[0,1,1]
    v_pk_mul_f32 v[152:153], v[144:145], v[144:145]
    v_pk_mul_f32 v[154:155], v[146:147], v[146:147]
    v_pk_fma_f32 v[152:153], v[152:153], v[138:139], v[136:137] op_sel:[0,0,1] op_sel_hi:[1,0,1]
    v_pk_fma_f32 v[154:155], v[154:155], v[138:139], v[136:137] op_sel:[0,0,1] op_sel_hi:[1,0,1]
    v_pk_mul_f32 v[152:153], v[152:153], v[144:145]
    v_pk_mul_f32 v[154:155], v[154:155], v[146:147]
    v_mfma_f32_16x16x32_bf16 v[108:111], a[184:187], v[96:99], v[108:111]
    v_exp_f32 v152, v152
    v_mfma_f32_16x16x32_bf16 v[108:111], a[188:191], v[100:103], v[108:111]
    s_waitcnt vmcnt(10)
    ds_read2st64_b32 v[30:31], v3 offset0:128 offset1:132
    ds_read2st64_b32 v[32:33], v3 offset0:136 offset1:140
    v_mfma_f32_16x16x32_bf16 v[112:115], a[64:67], v[40:43], 0
    buffer_load_dwordx4 v37, s[52:55], s83 offen offset:2048 lds
    v_exp_f32 v153, v153
    v_mfma_f32_16x16x32_bf16 v[112:115], a[68:71], v[44:47], v[112:115]
    v_exp_f32 v154, v154
    v_mfma_f32_16x16x32_bf16 v[112:115], a[72:75], v[48:51], v[112:115]
    v_exp_f32 v155, v155
    v_mfma_f32_16x16x32_bf16 v[112:115], a[76:79], v[52:55], v[112:115]
    v_mul_f32 v144, v144, v148
    v_mul_f32 v145, v145, v149
    v_mfma_f32_16x16x32_bf16 v[112:115], a[80:83], v[56:59], v[112:115]
    s_waitcnt lgkmcnt(0)
    v_max3_u32 v30, v30, v31, v32
    v_max_u32 v30, v30, v33
    v_mfma_f32_16x16x32_bf16 v[112:115], a[84:87], v[60:63], v[112:115]
    buffer_load_dwordx4 v38, s[52:55], s83 offen offset:3072 lds
    v_cmp_eq_u32 vcc, -1, v30
    v_mfma_f32_16x16x32_bf16 v[112:115], a[88:91], v[64:67], v[112:115]
    s_add_u32 m0, s85, 65536
    v_mul_f32 v146, v146, v150
    v_mul_f32 v147, v147, v151
    v_mfma_f32_16x16x32_bf16 v[112:115], a[92:95], v[68:71], v[112:115]
    s_cbranch_vccnz LX_h2
LR_h2:
    v_mfma_f32_16x16x32_bf16 v[112:115], a[192:195], v[72:75], v[112:115]
    s_barrier
    s_add_u32 s83, s73, 65536
    v_mfma_f32_16x16x32_bf16 v[112:115], a[196:199], v[76:79], v[112:115]
    buffer_load_dwordx4 v1, s[60:63], s83 offen offset:0 sc1 lds
    v_fma_f32 v152, v152, v139, v139
    v_mfma_f32_16x16x32_bf16 v[112:115], a[200:203], v[80:83], v[112:115]
    v_fma_f32 v153, v153, v139, v139
    v_fma_f32 v154, v154, v139, v139
    v_mfma_f32_16x16x32_bf16 v[112:115], a[204:207], v[84:87], v[112:115]
    v_fma_f32 v155, v155, v139, v139
    v_rcp_f32 v152, v152
    v_mfma_f32_16x16x32_bf16 v[112:115], a[208:211], v[88:91], v[112:115]
    buffer_load_dwordx4 v1, s[60:63], s83 offen offset:1024 sc1 lds
    v_rcp_f32 v153, v153
    v_mfma_f32_16x16x32_bf16 v[112:115], a[212:215], v[92:95], v[112:115]
    v_rcp_f32 v154, v154
    v_mfma_f32_16x16x32_bf16 v[112:115], a[216:219], v[96:99], v[112:115]
    v_rcp_f32 v155, v155
    v_mfma_f32_16x16x32_bf16 v[112:115], a[220:223], v[100:103], v[112:115]
    v_mul_f32 v144, v144, v152
    v_mul_f32 v145, v145, v153
    v_mfma_f32_16x16x32_bf16 v[116:119], a[96:99], v[40:43], 0
    ds_read_b128 v[40:43], v20 offset:32768
    buffer_load_dwordx4 v1, s[60:63], s83 offen offset:2048 sc1 lds
    v_mfma_f32_16x16x32_bf16 v[116:119], a[100:103], v[44:47], v[116:119]
    ds_read_b128 v[44:47], v20 offset:33792
    v_mul_f32 v146, v146, v154
    v_mfma_f32_16x16x32_bf16 v[116:119], a[104:107], v[48:51], v[116:119]
    ds_read_b128 v[48:51], v20 offset:34816
    v_mul_f32 v147, v147, v155
    v_mfma_f32_16x16x32_bf16 v[116:119], a[108:111], v[52:55], v[116:119]
    ds_read_b128 v[52:55], v20 offset:35840
    v_cvt_pk_bf16_f32 v158, v144, v145
    v_mfma_f32_16x16x32_bf16 v[116:119], a[112:115], v[56:59], v[116:119]
    ds_read_b128 v[56:59], v20 offset:36864
    v_cvt_pk_bf16_f32 v159, v146, v147
    v_mfma_f32_16x16x32_bf16 v[116:119], a[116:119], v[60:63], v[116:119]
Lpad_est0:
Lpad_5:
    s_cbranch_execz Lpad_retst
    ds_read_b128 v[60:63], v20 offset:37888
    buffer_load_dwordx4 v1, s[60:63], s83 offen offset:3072 sc1 lds
    v_mfma_f32_16x16x32_bf16 v[116:119], a[120:123], v[64:67], v[116:119]
    ds_read_b128 v[64:67], v20 offset:38912
    buffer_store_dwordx4 v[156:159], v1, s[40:43], s76 offen sc1
    v_mfma_f32_16x16x32_bf16 v[116:119], a[124:127], v[68:71], v[116:119]
    ds_read_b128 v[68:71], v20 offset:39936
    v_fma_f32 v144, v140, v120, v104
    v_mfma_f32_16x16x32_bf16 v[116:119], a[224:227], v[72:75], v[116:119]
    ds_read_b128 v[72:75], v20 offset:40960
    v_fma_f32 v145, v140, v121, v105
    v_mfma_f32_16x16x32_bf16 v[116:119], a[228:231], v[76:79], v[116:119]
    ds_read_b128 v[76:79], v20 offset:41984
    v_fma_f32 v146, v140, v122, v106
    v_mfma_f32_16x16x32_bf16 v[116:119], a[232:235], v[80:83], v[116:119]
    ds_read_b128 v[80:83], v20 offset:43008
    v_fma_f32 v147, v140, v123, v107
    v_mfma_f32_16x16x32_bf16 v[116:119], a[236:239], v[84:87], v[116:119]
    ds_read_b128 v[84:87], v20 offset:44032
    v_fma_f32 v148, v140, v124, v108
    v_mfma_f32_16x16x32_bf16 v[116:119], a[240:243], v[88:91], v[116:119]
    ds_read_b128 v[88:91], v20 offset:45056
    v_fma_f32 v149, v140, v125, v109
    v_mfma_f32_16x16x32_bf16 v[116:119], a[244:247], v[92:95], v[116:119]
    s_add_u32 m0, s85, 16384
    ds_read_b128 v[92:95], v20 offset:46080
    v_fma_f32 v150, v140, v126, v110
    v_mfma_f32_16x16x32_bf16 v[116:119], a[248:251], v[96:99], v[116:119]
    s_add_u32 s83, s47, 65536
    ds_read_b128 v[96:99], v20 offset:47104
    v_fma_f32 v151, v140, v127, v111
    v_mfma_f32_16x16x32_bf16 v[116:119], a[252:255], v[100:103], v[116:119]
    s_waitcnt vmcnt(13) lgkmcnt(11)
    ds_read_b128 v[100:103], v20 offset:48128
    ds_read_b64_tr_b16 v[164:165], v7 offset:0
    v_mfma_f32_16x16x32_bf16 v[104:107], a[0:3], v[40:43], 0
    s_waitcnt vmcnt(9)
    ds_read2st64_b32 v[30:31], v3 offset0:192 offset1:196
    ds_read2st64_b32 v[32:33], v3 offset0:200 offset1:204
    v_mfma_f32_16x16x32_bf16 v[104:107], a[4:7], v[44:47], v[104:107]
    s_add_u32 s76, s75, 57344
    buffer_load_dwordx4 v35, s[52:55], s83 offen offset:0 lds
    ds_read_b64_tr_b16 v[166:167], v7 offset:2048
    v_mfma_f32_16x16x32_bf16 v[104:107], a[8:11], v[48:51], v[104:107]
    ds_read_b64_tr_b16 v[168:169], v10 offset:0
    ds_read_b64_tr_b16 v[170:171], v10 offset:2048
    v_mfma_f32_16x16x32_bf16 v[104:107], a[12:15], v[52:55], v[104:107]
    s_waitcnt lgkmcnt(14)
    ds_read_b64_tr_b16 v[172:173], v13 offset:0
    ds_read_b64_tr_b16 v[174:175], v13 offset:2048
    v_mfma_f32_16x16x32_bf16 v[104:107], a[16:19], v[56:59], v[104:107]
    buffer_load_dwordx4 v36, s[52:55], s83 offen offset:1024 lds
    ds_read_b64_tr_b16 v[160:161], v4 offset:0
    v_mfma_f32_16x16x32_bf16 v[104:107], a[20:23], v[60:63], v[104:107]
    s_waitcnt lgkmcnt(6)
    v_max3_u32 v30, v30, v31, v32
    v_max_u32 v30, v30, v33
    v_mfma_f32_16x16x32_bf16 v[104:107], a[24:27], v[64:67], v[104:107]
    ds_read_b64_tr_b16 v[162:163], v4 offset:2048
    v_cmp_eq_u32 vcc, -1, v30
    v_mfma_f32_16x16x32_bf16 v[104:107], a[28:31], v[68:71], v[104:107]
    v_mul_f32 v152, v144, v144
    v_mul_f32 v153, v145, v145
    v_mfma_f32_16x16x32_bf16 v[104:107], a[128:131], v[72:75], v[104:107]
    s_cbranch_vccnz LX_h3
LR_h3:
    v_add_u32 v3, 65536, v3
    v_mfma_f32_16x16x32_bf16 v[104:107], a[132:135], v[76:79], v[104:107]
    s_barrier
    buffer_load_dwordx4 v37, s[52:55], s83 offen offset:2048 lds
    v_mfma_f32_16x16x32_bf16 v[104:107], a[136:139], v[80:83], v[104:107]
    v_mul_f32 v154, v146, v146
    v_mul_f32 v155, v147, v147
    v_mfma_f32_16x16x32_bf16 v[104:107], a[140:143], v[84:87], v[104:107]
    v_fma_f32 v152, v152, v142, v141
    v_fma_f32 v153, v153, v142, v141
    v_mfma_f32_16x16x32_bf16 v[104:107], a[144:147], v[88:91], v[104:107]
    buffer_load_dwordx4 v38, s[52:55], s83 offen offset:3072 lds
    v_fma_f32 v154, v154, v142, v141
    v_mfma_f32_16x16x32_bf16 v[104:107], a[148:151], v[92:95], v[104:107]
    s_add_u32 m0, s85, 0
    v_fma_f32 v155, v155, v142, v141
    v_mul_f32 v152, v152, v144
    v_mfma_f32_16x16x32_bf16 v[104:107], a[152:155], v[96:99], v[104:107]
    s_add_u32 s83, s47, 98304
    v_mul_f32 v153, v153, v145
    v_mul_f32 v154, v154, v146
    v_mfma_f32_16x16x32_bf16 v[104:107], a[156:159], v[100:103], v[104:107]
    v_mul_f32 v155, v155, v147
    v_exp_f32 v152, v152
    v_mfma_f32_16x16x32_bf16 v[108:111], a[32:35], v[40:43], 0
    s_waitcnt lgkmcnt(0)
    buffer_load_dwordx4 v35, s[52:55], s83 offen offset:0 lds
    v_exp_f32 v153, v153
    v_mfma_f32_16x16x32_bf16 v[108:111], a[36:39], v[44:47], v[108:111]
    v_exp_f32 v154, v154
    v_mfma_f32_16x16x32_bf16 v[108:111], a[40:43], v[48:51], v[108:111]
    v_exp_f32 v155, v155
    v_mfma_f32_16x16x32_bf16 v[108:111], a[44:47], v[52:55], v[108:111]
    v_mul_f32 v144, v144, v148
    v_mul_f32 v145, v145, v149
    v_mfma_f32_16x16x32_bf16 v[108:111], a[48:51], v[56:59], v[108:111]
    v_mul_f32 v146, v146, v150
    v_mul_f32 v147, v147, v151
    v_mfma_f32_16x16x32_bf16 v[108:111], a[52:55], v[60:63], v[108:111]
    buffer_load_dwordx4 v36, s[52:55], s83 offen offset:1024 lds
    v_fma_f32 v152, v152, v143, v143
    v_fma_f32 v153, v153, v143, v143
    v_fma_f32 v154, v154, v143, v143
    v_fma_f32 v155, v155, v143, v143
    v_rcp_f32 v152, v152
    v_rcp_f32 v153, v153
    v_rcp_f32 v154, v154
    v_rcp_f32 v155, v155
    v_mul_f32 v144, v144, v152
    v_mul_f32 v145, v145, v153
    v_mul_f32 v146, v146, v154
    v_mul_f32 v147, v147, v155
    v_cvt_pk_bf16_f32 v156, v144, v145
    v_cvt_pk_bf16_f32 v157, v146, v147
    v_mfma_f32_16x16x32_bf16 v[108:111], a[56:59], v[64:67], v[108:111]
    ds_read_b128 v[136:139], v22 offset:512
    v_pk_fma_f32 v[144:145], v[140:141], v[128:129], v[112:113] op_sel_hi:[0,1,1]
    v_pk_fma_f32 v[146:147], v[140:141], v[130:131], v[114:115] op_sel_hi:[0,1,1]
    v_pk_fma_f32 v[148:149], v[140:141], v[132:133], v[116:117] op_sel_hi:[0,1,1]
    v_pk_fma_f32 v[150:151], v[140:141], v[134:135], v[118:119] op_sel_hi:[0,1,1]
    v_pk_mul_f32 v[152:153], v[144:145], v[144:145]
    v_pk_mul_f32 v[154:155], v[146:147], v[146:147]
    v_pk_fma_f32 v[152:153], v[152:153], v[142:143], v[140:141] op_sel:[0,0,1] op_sel_hi:[1,0,1]
    v_pk_fma_f32 v[154:155], v[154:155], v[142:143], v[140:141] op_sel:[0,0,1] op_sel_hi:[1,0,1]
    v_pk_mul_f32 v[152:153], v[152:153], v[144:145]
    v_pk_mul_f32 v[154:155], v[154:155], v[146:147]
    v_mfma_f32_16x16x32_bf16 v[108:111], a[60:63], v[68:71], v[108:111]
    v_exp_f32 v152, v152
    v_mfma_f32_16x16x32_bf16 v[108:111], a[160:163], v[72:75], v[108:111]
    buffer_load_dwordx4 v37, s[52:55], s83 offen offset:2048 lds
    v_mfma_f32_16x16x32_bf16 v[108:111], a[164:167], v[76:79], v[108:111]
    v_exp_f32 v153, v153
    v_mfma_f32_16x16x32_bf16 v[108:111], a[168:171], v[80:83], v[108:111]
    v_exp_f32 v154, v154
    v_mfma_f32_16x16x32_bf16 v[108:111], a[172:175], v[84:87], v[108:111]
    v_exp_f32 v155, v155
    v_mfma_f32_16x16x32_bf16 v[108:111], a[176:179], v[88:91], v[108:111]
    buffer_load_dwordx4 v38, s[52:55], s83 offen offset:3072 lds
    v_mul_f32 v144, v144, v148
    v_mfma_f32_16x16x32_bf16 v[108:111], a[180:183], v[92:95], v[108:111]
    s_add_u32 m0, s85, 81920
    v_mul_f32 v145, v145, v149
    v_mul_f32 v146, v146, v150
    v_mfma_f32_16x16x32_bf16 v[108:111], a[184:187], v[96:99], v[108:111]
    s_add_u32 s83, s73, 81920
    v_mul_f32 v147, v147, v151
    v_fma_f32 v152, v152, v143, v143
    v_mfma_f32_16x16x32_bf16 v[108:111], a[188:191], v[100:103], v[108:111]
    v_fma_f32 v153, v153, v143, v143
    v_fma_f32 v154, v154, v143, v143
    v_mfma_f32_16x16x32_bf16 v[112:115], a[64:67], v[40:43], 0
    buffer_load_dwordx4 v1, s[60:63], s83 offen offset:0 sc1 lds
    v_fma_f32 v155, v155, v143, v143
    v_mfma_f32_16x16x32_bf16 v[112:115], a[68:71], v[44:47], v[112:115]
    v_rcp_f32 v152, v152
    v_mfma_f32_16x16x32_bf16 v[112:115], a[72:75], v[48:51], v[112:115]
    v_rcp_f32 v153, v153
    v_mfma_f32_16x16x32_bf16 v[112:115], a[76:79], v[52:55], v[112:115]
    v_rcp_f32 v154, v154
    v_mfma_f32_16x16x32_bf16 v[112:115], a[80:83], v[56:59], v[112:115]
    buffer_load_dwordx4 v1, s[60:63], s83 offen offset:1024 sc1 lds
    v_mfma_f32_16x16x32_bf16 v[112:115], a[84:87], v[60:63], v[112:115]
    v_rcp_f32 v155, v155
    v_mfma_f32_16x16x32_bf16 v[112:115], a[88:91], v[64:67], v[112:115]
    v_mul_f32 v144, v144, v152
    v_mul_f32 v145, v145, v153
    v_mfma_f32_16x16x32_bf16 v[112:115], a[92:95], v[68:71], v[112:115]
    v_mul_f32 v146, v146, v154
    v_mul_f32 v147, v147, v155
    v_mfma_f32_16x16x32_bf16 v[112:115], a[192:195], v[72:75], v[112:115]
    buffer_load_dwordx4 v1, s[60:63], s83 offen offset:2048 sc1 lds
    v_cvt_pk_bf16_f32 v158, v144, v145
    v_mfma_f32_16x16x32_bf16 v[112:115], a[196:199], v[76:79], v[112:115]
    s_waitcnt vmcnt(16)
    ds_read_b64_tr_b16 v[180:181], v9 offset:0
    v_cvt_pk_bf16_f32 v159, v146, v147
    v_mfma_f32_16x16x32_bf16 v[112:115], a[200:203], v[80:83], v[112:115]
    buffer_store_dwordx4 v[156:159], v1, s[40:43], s76 offen sc1
    ds_read_b64_tr_b16 v[182:183], v9 offset:2048
    v_mfma_f32_16x16x32_bf16 v[112:115], a[204:207], v[84:87], v[112:115]
    s_waitcnt lgkmcnt(2)
    v_fma_f32 v144, v136, v120, v104
    v_fma_f32 v145, v136, v121, v105
    v_mfma_f32_16x16x32_bf16 v[112:115], a[208:211], v[88:91], v[112:115]
    buffer_load_dwordx4 v1, s[60:63], s83 offen offset:3072 sc1 lds
    v_fma_f32 v146, v136, v122, v106
    v_mfma_f32_16x16x32_bf16 v[112:115], a[212:215], v[92:95], v[112:115]
    v_fma_f32 v147, v136, v123, v107
    v_fma_f32 v148, v136, v124, v108
    v_mfma_f32_16x16x32_bf16 v[112:115], a[216:219], v[96:99], v[112:115]
    v_fma_f32 v149, v136, v125, v109
    v_fma_f32 v150, v136, v126, v110
    v_mfma_f32_16x16x32_bf16 v[112:115], a[220:223], v[100:103], v[112:115]
    ds_read_b64_tr_b16 v[184:185], v12 offset:0
    v_fma_f32 v151, v136, v127, v111
    v_mfma_f32_16x16x32_bf16 v[116:119], a[96:99], v[40:43], 0
    ds_read_b128 v[40:43], v20 offset:49152
    ds_read_b64_tr_b16 v[186:187], v12 offset:2048
    v_mfma_f32_16x16x32_bf16 v[116:119], a[100:103], v[44:47], v[116:119]
    ds_read_b128 v[44:47], v20 offset:50176
    ds_read_b64_tr_b16 v[188:189], v15 offset:0
    v_mfma_f32_16x16x32_bf16 v[116:119], a[104:107], v[48:51], v[116:119]
    ds_read_b128 v[48:51], v20 offset:51200
    ds_read_b64_tr_b16 v[190:191], v15 offset:2048
    v_mfma_f32_16x16x32_bf16 v[116:119], a[108:111], v[52:55], v[116:119]
    ds_read_b128 v[52:55], v20 offset:52224
    ds_read_b64_tr_b16 v[176:177], v6 offset:0
    v_mfma_f32_16x16x32_bf16 v[116:119], a[112:115], v[56:59], v[116:119]
    ds_read_b128 v[56:59], v20 offset:53248
    ds_read_b64_tr_b16 v[178:179], v6 offset:2048
    v_mfma_f32_16x16x32_bf16 v[116:119], a[116:119], v[60:63], v[116:119]
    s_add_u32 m0, s85, 32768
    ds_read_b128 v[60:63], v20 offset:54272
    v_mul_f32 v152, v144, v144
    v_mfma_f32_16x16x32_bf16 v[116:119], a[120:123], v[64:67], v[116:119]
    s_add_u32 s83, s47, 131072
    ds_read_b128 v[64:67], v20 offset:55296
    v_mul_f32 v153, v145, v145
    v_mfma_f32_16x16x32_bf16 v[116:119], a[124:127], v[68:71], v[116:119]
    ds_read_b128 v[68:71], v20 offset:56320
    v_mul_f32 v154, v146, v146
    v_mfma_f32_16x16x32_bf16 v[116:119], a[224:227], v[72:75], v[116:119]
    ds_read_b128 v[72:75], v20 offset:57344
    buffer_load_dwordx4 v35, s[52:55], s83 offen offset:0 lds
    v_mfma_f32_16x16x32_bf16 v[116:119], a[228:231], v[76:79], v[116:119]
    ds_read_b128 v[76:79], v20 offset:58368
    v_mul_f32 v155, v147, v147
    v_mfma_f32_16x16x32_bf16 v[116:119], a[232:235], v[80:83], v[116:119]
    ds_read_b128 v[80:83], v20 offset:59392
    v_fma_f32 v152, v152, v138, v137
    v_mfma_f32_16x16x32_bf16 v[116:119], a[236:239], v[84:87], v[116:119]
    ds_read_b128 v[84:87], v20 offset:60416
    v_fma_f32 v153, v153, v138, v137
    v_mfma_f32_16x16x32_bf16 v[116:119], a[240:243], v[88:91], v[116:119]
    ds_read_b128 v[88:91], v20 offset:61440
    buffer_load_dwordx4 v36, s[52:55], s83 offen offset:1024 lds
    v_mfma_f32_16x16x32_bf16 v[116:119], a[244:247], v[92:95], v[116:119]
    ds_read_b128 v[92:95], v20 offset:62464
    v_fma_f32 v154, v154, v138, v137
    v_mfma_f32_16x16x32_bf16 v[116:119], a[248:251], v[96:99], v[116:119]
    ds_read_b128 v[96:99], v20 offset:63488
    v_fma_f32 v155, v155, v138, v137
    v_mfma_f32_16x16x32_bf16 v[116:119], a[252:255], v[100:103], v[116:119]
    s_waitcnt lgkmcnt(13)
    ds_read_b128 v[100:103], v20 offset:64512
    v_mul_f32 v152, v152, v144
    v_mfma_f32_16x16x32_bf16 v[104:107], a[0:3], v[40:43], 0
    s_waitcnt vmcnt(16)
    ds_read2st64_b32 v[30:31], v3 offset0:0 offset1:4
    ds_read2st64_b32 v[32:33], v3 offset0:8 offset1:12
    v_mfma_f32_16x16x32_bf16 v[104:107], a[4:7], v[44:47], v[104:107]
    s_add_u32 s76, s75, 114688
    buffer_load_dwordx4 v37, s[52:55], s83 offen offset:2048 lds
    v_mul_f32 v153, v153, v145
    v_mfma_f32_16x16x32_bf16 v[104:107], a[8:11], v[48:51], v[104:107]
    v_mul_f32 v154, v154, v146
    v_mul_f32 v155, v155, v147
    v_mfma_f32_16x16x32_bf16 v[104:107], a[12:15], v[52:55], v[104:107]
    s_waitcnt lgkmcnt(10)
    v_exp_f32 v152, v152
    v_mfma_f32_16x16x32_bf16 v[104:107], a[16:19], v[56:59], v[104:107]
    buffer_load_dwordx4 v38, s[52:55], s83 offen offset:3072 lds
    v_exp_f32 v153, v153
    v_mfma_f32_16x16x32_bf16 v[104:107], a[20:23], v[60:63], v[104:107]
    s_waitcnt lgkmcnt(0)
    v_max3_u32 v30, v30, v31, v32
    v_max_u32 v30, v30, v33
    v_mfma_f32_16x16x32_bf16 v[104:107], a[24:27], v[64:67], v[104:107]
    s_add_u32 m0, s85, 131072
    v_cmp_eq_u32 vcc, -1, v30
    v_exp_f32 v154, v154
    v_mfma_f32_16x16x32_bf16 v[104:107], a[28:31], v[68:71], v[104:107]
    s_add_u32 s83, s47, 163840
    v_exp_f32 v155, v155
    v_mfma_f32_16x16x32_bf16 v[104:107], a[128:131], v[72:75], v[104:107]
    s_cbranch_vccnz LX_h4
LR_h4:
    v_mfma_f32_16x16x32_bf16 v[104:107], a[132:135], v[76:79], v[104:107]
    s_barrier
    buffer_load_dwordx4 v35, s[52:55], s83 offen offset:0 lds
    v_mfma_f32_16x16x32_bf16 v[104:107], a[136:139], v[80:83], v[104:107]
    v_mul_f32 v144, v144, v148
    v_mul_f32 v145, v145, v149
    v_mfma_f32_16x16x32_bf16 v[104:107], a[140:143], v[84:87], v[104:107]
    v_mul_f32 v146, v146, v150
    v_mul_f32 v147, v147, v151
    v_mfma_f32_16x16x32_bf16 v[104:107], a[144:147], v[88:91], v[104:107]
    buffer_load_dwordx4 v36, s[52:55], s83 offen offset:1024 lds
    v_fma_f32 v152, v152, v139, v139
    v_mfma_f32_16x16x32_bf16 v[104:107], a[148:151], v[92:95], v[104:107]
    v_fma_f32 v153, v153, v139, v139
    v_fma_f32 v154, v154, v139, v139
    v_mfma_f32_16x16x32_bf16 v[104:107], a[152:155], v[96:99], v[104:107]
    v_fma_f32 v155, v155, v139, v139
    v_rcp_f32 v152, v152
    v_mfma_f32_16x16x32_bf16 v[104:107], a[156:159], v[100:103], v[104:107]
    v_rcp_f32 v153, v153
    v_mfma_f32_16x16x32_bf16 v[108:111], a[32:35], v[40:43], 0
    buffer_load_dwordx4 v37, s[52:55], s83 offen offset:2048 lds
    v_rcp_f32 v154, v154
    v_mfma_f32_16x16x32_bf16 v[108:111], a[36:39], v[44:47], v[108:111]
    v_rcp_f32 v155, v155
    v_mfma_f32_16x16x32_bf16 v[108:111], a[40:43], v[48:51], v[108:111]
    v_mul_f32 v144, v144, v152
    v_mul_f32 v145, v145, v153
    v_mfma_f32_16x16x32_bf16 v[108:111], a[44:47], v[52:55], v[108:111]
    v_mul_f32 v146, v146, v154
    v_mul_f32 v147, v147, v155
    v_mfma_f32_16x16x32_bf16 v[108:111], a[48:51], v[56:59], v[108:111]
    v_cvt_pk_bf16_f32 v156, v144, v145
    v_cvt_pk_bf16_f32 v157, v146, v147
    v_mfma_f32_16x16x32_bf16 v[108:111], a[52:55], v[60:63], v[108:111]
    buffer_load_dwordx4 v38, s[52:55], s83 offen offset:3072 lds
    ds_read_b128 v[140:143], v22 offset:768
    v_pk_fma_f32 v[144:145], v[136:137], v[128:129], v[112:113] op_sel_hi:[0,1,1]
    v_pk_fma_f32 v[146:147], v[136:137], v[130:131], v[114:115] op_sel_hi:[0,1,1]
    v_pk_fma_f32 v[148:149], v[136:137], v[132:133], v[116:117] op_sel_hi:[0,1,1]
    v_pk_fma_f32 v[150:151], v[136:137], v[134:135], v[118:119] op_sel_hi:[0,1,1]
    v_pk_mul_f32 v[152:153], v[144:145], v[144:145]
    v_pk_mul_f32 v[154:155], v[146:147], v[146:147]
    v_pk_fma_f32 v[152:153], v[152:153], v[138:139], v[136:137] op_sel:[0,0,1] op_sel_hi:[1,0,1]
    v_pk_fma_f32 v[154:155], v[154:155], v[138:139], v[136:137] op_sel:[0,0,1] op_sel_hi:[1,0,1]
    v_pk_mul_f32 v[152:153], v[152:153], v[144:145]
    v_pk_mul_f32 v[154:155], v[154:155], v[146:147]
    v_mfma_f32_16x16x32_bf16 v[108:111], a[56:59], v[64:67], v[108:111]
    s_add_u32 m0, s85, 98304
    v_exp_f32 v152, v152
    v_mfma_f32_16x16x32_bf16 v[108:111], a[60:63], v[68:71], v[108:111]
    s_add_u32 s83, s73, 98304
    v_exp_f32 v153, v153
    v_mfma_f32_16x16x32_bf16 v[108:111], a[160:163], v[72:75], v[108:111]
    buffer_load_dwordx4 v1, s[60:63], s83 offen offset:0 sc1 lds
    v_mfma_f32_16x16x32_bf16 v[108:111], a[164:167], v[76:79], v[108:111]
    v_exp_f32 v154, v154
    v_mfma_f32_16x16x32_bf16 v[108:111], a[168:171], v[80:83], v[108:111]
    v_exp_f32 v155, v155
    v_mfma_f32_16x16x32_bf16 v[108:111], a[172:175], v[84:87], v[108:111]
    v_mul_f32 v144, v144, v148
    v_mul_f32 v145, v145, v149
    v_mfma_f32_16x16x32_bf16 v[108:111], a[176:179], v[88:91], v[108:111]
    buffer_load_dwordx4 v1, s[60:63], s83 offen offset:1024 sc1 lds
    v_mul_f32 v146, v146, v150
    v_mfma_f32_16x16x32_bf16 v[108:111], a[180:183], v[92:95], v[108:111]
    v_mul_f32 v147, v147, v151
    v_fma_f32 v152, v152, v139, v139
    v_mfma_f32_16x16x32_bf16 v[108:111], a[184:187], v[96:99], v[108:111]
    v_fma_f32 v153, v153, v139, v139
    v_fma_f32 v154, v154, v139, v139
    v_mfma_f32_16x16x32_bf16 v[108:111], a[188:191], v[100:103], v[108:111]
    v_fma_f32 v155, v155, v139, v139
    v_mfma_f32_16x16x32_bf16 v[112:115], a[64:67], v[40:43], 0
    s_waitcnt vmcnt(19)
    buffer_load_dwordx4 v1, s[60:63], s83 offen offset:2048 sc1 lds
    ds_read_b64_tr_b16 v[196:197], v7 offset:16384
    v_mfma_f32_16x16x32_bf16 v[112:115], a[68:71], v[44:47], v[112:115]
    v_rcp_f32 v152, v152
    v_mfma_f32_16x16x32_bf16 v[112:115], a[72:75], v[48:51], v[112:115]
    v_rcp_f32 v153, v153
    v_mfma_f32_16x16x32_bf16 v[112:115], a[76:79], v[52:55], v[112:115]
    v_rcp_f32 v154, v154
    v_mfma_f32_16x16x32_bf16 v[112:115], a[80:83], v[56:59], v[112:115]
    buffer_load_dwordx4 v1, s[60:63], s83 offen offset:3072 sc1 lds
    ds_read_b64_tr_b16 v[198:199], v7 offset:18432
    v_mfma_f32_16x16x32_bf16 v[112:115], a[84:87], v[60:63], v[112:115]
    v_rcp_f32 v155, v155
    v_mfma_f32_16x16x32_bf16 v[112:115], a[88:91], v[64:67], v[112:115]
    v_mul_f32 v144, v144, v152
    v_mul_f32 v145, v145, v153
    v_mfma_f32_16x16x32_bf16 v[112:115], a[92:95], v[68:71], v[112:115]
    v_mul_f32 v146, v146, v154
    v_mul_f32 v147, v147, v155
    v_mfma_f32_16x16x32_bf16 v[112:115], a[192:195], v[72:75], v[112:115]
    v_cvt_pk_bf16_f32 v158, v144, v145
    v_cvt_pk_bf16_f32 v159, v146, v147
    v_mfma_f32_16x16x32_bf16 v[112:115], a[196:199], v[76:79], v[112:115]
    buffer_store_dwordx4 v[156:159], v1, s[40:43], s76 offen sc1
    ds_read_b64_tr_b16 v[200:201], v10 offset:16384
    v_mfma_f32_16x16x32_bf16 v[112:115], a[200:203], v[80:83], v[112:115]
    ds_read_b64_tr_b16 v[202:203], v10 offset:18432
    ds_read_b64_tr_b16 v[204:205], v13 offset:16384
    v_mfma_f32_16x16x32_bf16 v[112:115], a[204:207], v[84:87], v[112:115]
    ds_read_b64_tr_b16 v[206:207], v13 offset:18432
    ds_read_b64_tr_b16 v[192:193], v4 offset:16384
    v_mfma_f32_16x16x32_bf16 v[112:115], a[208:211], v[88:91], v[112:115]
    s_waitcnt lgkmcnt(7)
    ds_read_b64_tr_b16 v[194:195], v4 offset:18432
    v_fma_f32 v144, v140, v120, v104
    v_mfma_f32_16x16x32_bf16 v[112:115], a[212:215], v[92:95], v[112:115]
    s_add_u32 m0, s85, 49152
    v_fma_f32 v145, v140, v121, v105
    v_fma_f32 v146, v140, v122, v106
    v_mfma_f32_16x16x32_bf16 v[112:115], a[216:219], v[96:99], v[112:115]
    s_add_u32 s83, s47, 196608
    v_fma_f32 v147, v140, v123, v107
    v_fma_f32 v148, v140, v124, v108
    v_mfma_f32_16x16x32_bf16 v[112:115], a[220:223], v[100:103], v[112:115]
    v_fma_f32 v149, v140, v125, v109
    v_fma_f32 v150, v140, v126, v110
    v_mfma_f32_16x16x32_bf16 v[116:119], a[96:99], v[40:43], 0
    ds_read_b128 v[40:43], v21 offset:0
    buffer_load_dwordx4 v35, s[52:55], s83 offen offset:0 lds
    v_mfma_f32_16x16x32_bf16 v[116:119], a[100:103], v[44:47], v[116:119]
    ds_read_b128 v[44:47], v21 offset:1024
    v_fma_f32 v151, v140, v127, v111
    v_mfma_f32_16x16x32_bf16 v[116:119], a[104:107], v[48:51], v[116:119]
    ds_read_b128 v[48:51], v21 offset:2048
    v_mul_f32 v152, v144, v144
    v_mfma_f32_16x16x32_bf16 v[116:119], a[108:111], v[52:55], v[116:119]
    ds_read_b128 v[52:55], v21 offset:3072
    v_mul_f32 v153, v145, v145
    v_mfma_f32_16x16x32_bf16 v[116:119], a[112:115], v[56:59], v[116:119]
    ds_read_b128 v[56:59], v21 offset:4096
    buffer_load_dwordx4 v36, s[52:55], s83 offen offset:1024 lds
    v_mfma_f32_16x16x32_bf16 v[116:119], a[116:119], v[60:63], v[116:119]
    ds_read_b128 v[60:63], v21 offset:5120
    v_mul_f32 v154, v146, v146
    v_mfma_f32_16x16x32_bf16 v[116:119], a[120:123], v[64:67], v[116:119]
    ds_read_b128 v[64:67], v21 offset:6144
    v_mul_f32 v155, v147, v147
    v_mfma_f32_16x16x32_bf16 v[116:119], a[124:127], v[68:71], v[116:119]
    ds_read_b128 v[68:71], v21 offset:7168
    v_fma_f32 v152, v152, v142, v141
    v_mfma_f32_16x16x32_bf16 v[116:119], a[224:227], v[72:75], v[116:119]
    ds_read_b128 v[72:75], v21 offset:8192
    buffer_load_dwordx4 v37, s[52:55], s83 offen offset:2048 lds
    v_mfma_f32_16x16x32_bf16 v[116:119], a[228:231], v[76:79], v[116:119]
    s_waitcnt vmcnt(17)
    ds_read_b128 v[76:79], v21 offset:9216
    buffer_store_dword v39, off, s[40:43], s77 offset:0 sc1
    v_mfma_f32_16x16x32_bf16 v[116:119], a[232:235], v[80:83], v[116:119]
    ds_read_b128 v[80:83], v21 offset:10240
    v_fma_f32 v153, v153, v142, v141
    v_mfma_f32_16x16x32_bf16 v[116:119], a[236:239], v[84:87], v[116:119]
    ds_read_b128 v[84:87], v21 offset:11264
    v_fma_f32 v154, v154, v142, v141
    v_mfma_f32_16x16x32_bf16 v[116:119], a[240:243], v[88:91], v[116:119]
    ds_read_b128 v[88:91], v21 offset:12288
    buffer_load_dwordx4 v38, s[52:55], s83 offen offset:3072 lds
    v_mfma_f32_16x16x32_bf16 v[116:119], a[244:247], v[92:95], v[116:119]
    s_add_u32 m0, s85, 16384
    ds_read_b128 v[92:95], v21 offset:13312
    v_fma_f32 v155, v155, v142, v141
    v_mfma_f32_16x16x32_bf16 v[116:119], a[248:251], v[96:99], v[116:119]
    s_add_u32 s83, s47, 229376
    ds_read_b128 v[96:99], v21 offset:14336
    v_mul_f32 v152, v152, v144
    v_mfma_f32_16x16x32_bf16 v[116:119], a[252:255], v[100:103], v[116:119]
    s_waitcnt lgkmcnt(11)
    ds_read_b128 v[100:103], v21 offset:15360
    v_mul_f32 v153, v153, v145
    v_mfma_f32_16x16x32_bf16 v[104:107], a[0:3], v[40:43], 0
    s_waitcnt vmcnt(18)
    ds_read2st64_b32 v[30:31], v3 offset0:64 offset1:68
    ds_read2st64_b32 v[32:33], v3 offset0:72 offset1:76
    v_mfma_f32_16x16x32_bf16 v[104:107], a[4:7], v[44:47], v[104:107]
    s_add_u32 s76, s75, 172032
    buffer_load_dwordx4 v35, s[52:55], s83 offen offset:0 lds
    v_mul_f32 v154, v154, v146
    v_mfma_f32_16x16x32_bf16 v[104:107], a[8:11], v[48:51], v[104:107]
    v_mul_f32 v155, v155, v147
    v_exp_f32 v152, v152
    v_mfma_f32_16x16x32_bf16 v[104:107], a[12:15], v[52:55], v[104:107]
    s_waitcnt lgkmcnt(10)
    v_exp_f32 v153, v153
    v_mfma_f32_16x16x32_bf16 v[104:107], a[16:19], v[56:59], v[104:107]
    buffer_load_dwordx4 v36, s[52:55], s83 offen offset:1024 lds
    v_exp_f32 v154, v154
    v_mfma_f32_16x16x32_bf16 v[104:107], a[20:23], v[60:63], v[104:107]
    s_waitcnt lgkmcnt(0)
    v_max3_u32 v30, v30, v31, v32
    v_max_u32 v30, v30, v33
    v_mfma_f32_16x16x32_bf16 v[104:107], a[24:27], v[64:67], v[104:107]
    v_cmp_eq_u32 vcc, -1, v30
    v_exp_f32 v155, v155
    v_mfma_f32_16x16x32_bf16 v[104:107], a[28:31], v[68:71], v[104:107]
    v_mul_f32 v144, v144, v148
    v_mul_f32 v145, v145, v149
    v_mfma_f32_16x16x32_bf16 v[104:107], a[128:131], v[72:75], v[104:107]
    s_cbranch_vccnz LX_h5
LR_h5:
    v_mfma_f32_16x16x32_bf16 v[104:107], a[132:135], v[76:79], v[104:107]
    s_barrier
    buffer_load_dwordx4 v37, s[52:55], s83 offen offset:2048 lds
    v_mfma_f32_16x16x32_bf16 v[104:107], a[136:139], v[80:83], v[104:107]
    v_mul_f32 v146, v146, v150
    v_mul_f32 v147, v147, v151
    v_mfma_f32_16x16x32_bf16 v[104:107], a[140:143], v[84:87], v[104:107]
    v_fma_f32 v152, v152, v143, v143
    v_fma_f32 v153, v153, v143, v143
    v_mfma_f32_16x16x32_bf16 v[104:107], a[144:147], v[88:91], v[104:107]
    buffer_load_dwordx4 v38, s[52:55], s83 offen offset:3072 lds
    v_fma_f32 v154, v154, v143, v143
    v_mfma_f32_16x16x32_bf16 v[104:107], a[148:151], v[92:95], v[104:107]
    s_add_u32 m0, s85, 65536
    ds_read_b128 v[136:139], v22 offset:1024
    v_fma_f32 v155, v155, v143, v143
    v_mfma_f32_16x16x32_bf16 v[104:107], a[152:155], v[96:99], v[104:107]
    s_add_u32 s83, s47, 262144
    v_rcp_f32 v152, v152
    v_mfma_f32_16x16x32_bf16 v[104:107], a[156:159], v[100:103], v[104:107]
    v_rcp_f32 v153, v153
    v_mfma_f32_16x16x32_bf16 v[108:111], a[32:35], v[40:43], 0
    buffer_load_dwordx4 v35, s[52:55], s83 offen offset:0 lds
    v_rcp_f32 v154, v154
    v_mfma_f32_16x16x32_bf16 v[108:111], a[36:39], v[44:47], v[108:111]
    v_rcp_f32 v155, v155
    v_mfma_f32_16x16x32_bf16 v[108:111], a[40:43], v[48:51], v[108:111]
    v_mul_f32 v144, v144, v152
    v_mul_f32 v145, v145, v153
    v_mfma_f32_16x16x32_bf16 v[108:111], a[44:47], v[52:55], v[108:111]
    v_mul_f32 v146, v146, v154
    v_mul_f32 v147, v147, v155
    v_mfma_f32_16x16x32_bf16 v[108:111], a[48:51], v[56:59], v[108:111]
    v_cvt_pk_bf16_f32 v156, v144, v145
    v_cvt_pk_bf16_f32 v157, v146, v147
    v_mfma_f32_16x16x32_bf16 v[108:111], a[52:55], v[60:63], v[108:111]
    buffer_load_dwordx4 v36, s[52:55], s83 offen offset:1024 lds
    ds_read_b64_tr_b16 v[212:213], v7 offset:0
    v_pk_fma_f32 v[144:145], v[140:141], v[128:129], v[112:113] op_sel_hi:[0,1,1]
    v_pk_fma_f32 v[146:147], v[140:141], v[130:131], v[114:115] op_sel_hi:[0,1,1]
    v_pk_fma_f32 v[148:149], v[140:141], v[132:133], v[116:117] op_sel_hi:[0,1,1]
    v_pk_fma_f32 v[150:151], v[140:141], v[134:135], v[118:119] op_sel_hi:[0,1,1]
    v_pk_mul_f32 v[152:153], v[144:145], v[144:145]
    v_pk_mul_f32 v[154:155], v[146:147], v[146:147]
    v_pk_fma_f32 v[152:153], v[152:153], v[142:143], v[140:141] op_sel:[0,0,1] op_sel_hi:[1,0,1]
    v_pk_fma_f32 v[154:155], v[154:155], v[142:143], v[140:141] op_sel:[0,0,1] op_sel_hi:[1,0,1]
    v_pk_mul_f32 v[152:153], v[152:153], v[144:145]
    v_pk_mul_f32 v[154:155], v[154:155], v[146:147]
    v_mfma_f32_16x16x32_bf16 v[108:111], a[56:59], v[64:67], v[108:111]
    ds_read_b64_tr_b16 v[214:215], v7 offset:2048
    ds_read_b64_tr_b16 v[216:217], v10 offset:0
    v_mfma_f32_16x16x32_bf16 v[108:111], a[60:63], v[68:71], v[108:111]
    ds_read_b64_tr_b16 v[218:219], v10 offset:2048
    ds_read_b64_tr_b16 v[220:221], v13 offset:0
    v_mfma_f32_16x16x32_bf16 v[108:111], a[160:163], v[72:75], v[108:111]
    buffer_load_dwordx4 v37, s[52:55], s83 offen offset:2048 lds
    ds_read_b64_tr_b16 v[222:223], v13 offset:2048
    v_mfma_f32_16x16x32_bf16 v[108:111], a[164:167], v[76:79], v[108:111]
    ds_read_b64_tr_b16 v[208:209], v4 offset:0
    ds_read_b64_tr_b16 v[210:211], v4 offset:2048
    v_mfma_f32_16x16x32_bf16 v[108:111], a[168:171], v[80:83], v[108:111]
    v_exp_f32 v152, v152
    v_mfma_f32_16x16x32_bf16 v[108:111], a[172:175], v[84:87], v[108:111]
    v_exp_f32 v153, v153
    v_mfma_f32_16x16x32_bf16 v[108:111], a[176:179], v[88:91], v[108:111]
    buffer_load_dwordx4 v38, s[52:55], s83 offen offset:3072 lds
    v_mfma_f32_16x16x32_bf16 v[108:111], a[180:183], v[92:95], v[108:111]
    s_add_u32 m0, s85, 0
    v_exp_f32 v154, v154
    v_mfma_f32_16x16x32_bf16 v[108:111], a[184:187], v[96:99], v[108:111]
    s_add_u32 s83, s47, 294912
    v_exp_f32 v155, v155
    v_mfma_f32_16x16x32_bf16 v[108:111], a[188:191], v[100:103], v[108:111]
    v_mul_f32 v144, v144, v148
    v_mul_f32 v145, v145, v149
    v_mfma_f32_16x16x32_bf16 v[112:115], a[64:67], v[40:43], 0
    s_waitcnt lgkmcnt(0)
    buffer_load_dwordx4 v35, s[52:55], s83 offen offset:0 lds
    v_mul_f32 v146, v146, v150
    v_mfma_f32_16x16x32_bf16 v[112:115], a[68:71], v[44:47], v[112:115]
    v_mul_f32 v147, v147, v151
    v_fma_f32 v152, v152, v143, v143
    v_mfma_f32_16x16x32_bf16 v[112:115], a[72:75], v[48:51], v[112:115]
    v_fma_f32 v153, v153, v143, v143
    v_fma_f32 v154, v154, v143, v143
    v_mfma_f32_16x16x32_bf16 v[112:115], a[76:79], v[52:55], v[112:115]
    v_fma_f32 v155, v155, v143, v143
    v_mfma_f32_16x16x32_bf16 v[112:115], a[80:83], v[56:59], v[112:115]
    buffer_load_dwordx4 v36, s[52:55], s83 offen offset:1024 lds
    v_mfma_f32_16x16x32_bf16 v[112:115], a[84:87], v[60:63], v[112:115]
    v_rcp_f32 v152, v152
    v_mfma_f32_16x16x32_bf16 v[112:115], a[88:91], v[64:67], v[112:115]
    v_rcp_f32 v153, v153
    v_mfma_f32_16x16x32_bf16 v[112:115], a[92:95], v[68:71], v[112:115]
    v_rcp_f32 v154, v154
    v_mfma_f32_16x16x32_bf16 v[112:115], a[192:195], v[72:75], v[112:115]
    buffer_load_dwordx4 v37, s[52:55], s83 offen offset:2048 lds
    v_mfma_f32_16x16x32_bf16 v[112:115], a[196:199], v[76:79], v[112:115]
    v_rcp_f32 v155, v155
    v_mfma_f32_16x16x32_bf16 v[112:115], a[200:203], v[80:83], v[112:115]
    v_mul_f32 v144, v144, v152
    v_mul_f32 v145, v145, v153
    v_mfma_f32_16x16x32_bf16 v[112:115], a[204:207], v[84:87], v[112:115]
Lpad_est1:
Lpad_6:
    s_cbranch_execz Lpad_retst
    v_mul_f32 v146, v146, v154
    v_mul_f32 v147, v147, v155
    v_mfma_f32_16x16x32_bf16 v[112:115], a[208:211], v[88:91], v[112:115]
    v_cvt_pk_bf16_f32 v158, v144, v145
    v_cvt_pk_bf16_f32 v159, v146, v147
    v_mfma_f32_16x16x32_bf16 v[112:115], a[212:215], v[92:95], v[112:115]
    buffer_load_dwordx4 v38, s[52:55], s83 offen offset:3072 lds
    buffer_store_dwordx4 v[156:159], v1, s[40:43], s76 offen sc1
    v_mfma_f32_16x16x32_bf16 v[112:115], a[216:219], v[96:99], v[112:115]
    s_add_u32 m0, s85, 114688
    v_fma_f32 v144, v136, v120, v104
    v_fma_f32 v145, v136, v121, v105
    v_mfma_f32_16x16x32_bf16 v[112:115], a[220:223], v[100:103], v[112:115]
    s_add_u32 s83, s73, 114688
    v_fma_f32 v146, v136, v122, v106
    v_fma_f32 v147, v136, v123, v107
    v_mfma_f32_16x16x32_bf16 v[116:119], a[96:99], v[40:43], 0
    ds_read_b128 v[40:43], v21 offset:16384
    buffer_load_dwordx4 v1, s[60:63], s83 offen offset:0 sc1 lds
    v_mfma_f32_16x16x32_bf16 v[116:119], a[100:103], v[44:47], v[116:119]
    ds_read_b128 v[44:47], v21 offset:17408
    v_fma_f32 v148, v136, v124, v108
    v_mfma_f32_16x16x32_bf16 v[116:119], a[104:107], v[48:51], v[116:119]
    ds_read_b128 v[48:51], v21 offset:18432
    v_fma_f32 v149, v136, v125, v109
    v_mfma_f32_16x16x32_bf16 v[116:119], a[108:111], v[52:55], v[116:119]
    ds_read_b128 v[52:55], v21 offset:19456
    v_fma_f32 v150, v136, v126, v110
    v_mfma_f32_16x16x32_bf16 v[116:119], a[112:115], v[56:59], v[116:119]
    ds_read_b128 v[56:59], v21 offset:20480
    buffer_load_dwordx4 v1, s[60:63], s83 offen offset:1024 sc1 lds
    v_mfma_f32_16x16x32_bf16 v[116:119], a[116:119], v[60:63], v[116:119]
    ds_read_b128 v[60:63], v21 offset:21504
    v_fma_f32 v151, v136, v127, v111
    v_mfma_f32_16x16x32_bf16 v[116:119], a[120:123], v[64:67], v[116:119]
    ds_read_b128 v[64:67], v21 offset:22528
    v_mul_f32 v152, v144, v144
    v_mfma_f32_16x16x32_bf16 v[116:119], a[124:127], v[68:71], v[116:119]
    ds_read_b128 v[68:71], v21 offset:23552
    v_mul_f32 v153, v145, v145
    v_mfma_f32_16x16x32_bf16 v[116:119], a[224:227], v[72:75], v[116:119]
    ds_read_b128 v[72:75], v21 offset:24576
    buffer_load_dwordx4 v1, s[60:63], s83 offen offset:2048 sc1 lds
    v_mfma_f32_16x16x32_bf16 v[116:119], a[228:231], v[76:79], v[116:119]
    ds_read_b128 v[76:79], v21 offset:25600
    v_mul_f32 v154, v146, v146
    v_mfma_f32_16x16x32_bf16 v[116:119], a[232:235], v[80:83], v[116:119]
    ds_read_b128 v[80:83], v21 offset:26624
    v_mul_f32 v155, v147, v147
    v_mfma_f32_16x16x32_bf16 v[116:119], a[236:239], v[84:87], v[116:119]
    ds_read_b128 v[84:87], v21 offset:27648
    v_fma_f32 v152, v152, v138, v137
    v_mfma_f32_16x16x32_bf16 v[116:119], a[240:243], v[88:91], v[116:119]
    ds_read_b128 v[88:91], v21 offset:28672
    buffer_load_dwordx4 v1, s[60:63], s83 offen offset:3072 sc1 lds
    v_mfma_f32_16x16x32_bf16 v[116:119], a[244:247], v[92:95], v[116:119]
    ds_read_b128 v[92:95], v21 offset:29696
    v_fma_f32 v153, v153, v138, v137
    v_mfma_f32_16x16x32_bf16 v[116:119], a[248:251], v[96:99], v[116:119]
    ds_read_b128 v[96:99], v21 offset:30720
    v_fma_f32 v154, v154, v138, v137
    v_mfma_f32_16x16x32_bf16 v[116:119], a[252:255], v[100:103], v[116:119]
    s_waitcnt lgkmcnt(11)
    ds_read_b128 v[100:103], v21 offset:31744
    v_fma_f32 v155, v155, v138, v137
    v_mfma_f32_16x16x32_bf16 v[104:107], a[0:3], v[40:43], 0
    s_waitcnt vmcnt(23)
    ds_read2st64_b32 v[30:31], v3 offset0:128 offset1:132
    ds_read2st64_b32 v[32:33], v3 offset0:136 offset1:140
    v_mfma_f32_16x16x32_bf16 v[104:107], a[4:7], v[44:47], v[104:107]
    s_add_u32 s76, s75, 229376
    v_mul_f32 v152, v152, v144
    v_mul_f32 v153, v153, v145
    v_mfma_f32_16x16x32_bf16 v[104:107], a[8:11], v[48:51], v[104:107]
    v_mul_f32 v154, v154, v146
    v_mul_f32 v155, v155, v147
    v_mfma_f32_16x16x32_bf16 v[104:107], a[12:15], v[52:55], v[104:107]
    s_waitcnt lgkmcnt(10)
    v_exp_f32 v152, v152
    v_mfma_f32_16x16x32_bf16 v[104:107], a[16:19], v[56:59], v[104:107]
    v_exp_f32 v153, v153
    v_mfma_f32_16x16x32_bf16 v[104:107], a[20:23], v[60:63], v[104:107]
    s_waitcnt lgkmcnt(0)
    v_max3_u32 v30, v30, v31, v32
    v_max_u32 v30, v30, v33
    v_mfma_f32_16x16x32_bf16 v[104:107], a[24:27], v[64:67], v[104:107]
    v_cmp_eq_u32 vcc, -1, v30
    v_exp_f32 v154, v154
    v_mfma_f32_16x16x32_bf16 v[104:107], a[28:31], v[68:71], v[104:107]
    s_add_u32 m0, s85, 81920
    v_exp_f32 v155, v155
    v_mfma_f32_16x16x32_bf16 v[104:107], a[128:131], v[72:75], v[104:107]
    s_cbranch_vccnz LX_h6
LR_h6:
    v_mfma_f32_16x16x32_bf16 v[104:107], a[132:135], v[76:79], v[104:107]
    s_barrier
    v_mul_f32 v144, v144, v148
    v_mfma_f32_16x16x32_bf16 v[104:107], a[136:139], v[80:83], v[104:107]
    s_add_u32 s83, s47, 327680
    buffer_load_dwordx4 v35, s[52:55], s83 offen offset:0 lds
    v_mul_f32 v145, v145, v149
    v_mfma_f32_16x16x32_bf16 v[104:107], a[140:143], v[84:87], v[104:107]
    v_mul_f32 v146, v146, v150
    v_mul_f32 v147, v147, v151
    v_mfma_f32_16x16x32_bf16 v[104:107], a[144:147], v[88:91], v[104:107]
    v_fma_f32 v152, v152, v139, v139
    v_fma_f32 v153, v153, v139, v139
    v_mfma_f32_16x16x32_bf16 v[104:107], a[148:151], v[92:95], v[104:107]
    v_fma_f32 v154, v154, v139, v139
    v_fma_f32 v155, v155, v139, v139
    v_mfma_f32_16x16x32_bf16 v[104:107], a[152:155], v[96:99], v[104:107]
    buffer_load_dwordx4 v36, s[52:55], s83 offen offset:1024 lds
    v_rcp_f32 v152, v152
    v_mfma_f32_16x16x32_bf16 v[104:107], a[156:159], v[100:103], v[104:107]
    v_rcp_f32 v153, v153
    v_mfma_f32_16x16x32_bf16 v[108:111], a[32:35], v[40:43], 0
    v_rcp_f32 v154, v154
    v_mfma_f32_16x16x32_bf16 v[108:111], a[36:39], v[44:47], v[108:111]
    v_rcp_f32 v155, v155
    v_mfma_f32_16x16x32_bf16 v[108:111], a[40:43], v[48:51], v[108:111]
    buffer_load_dwordx4 v37, s[52:55], s83 offen offset:2048 lds
    v_mul_f32 v144, v144, v152
    v_mfma_f32_16x16x32_bf16 v[108:111], a[44:47], v[52:55], v[108:111]
    v_mul_f32 v145, v145, v153
    v_mul_f32 v146, v146, v154
    v_mfma_f32_16x16x32_bf16 v[108:111], a[48:51], v[56:59], v[108:111]
    v_mul_f32 v147, v147, v155
    v_cvt_pk_bf16_f32 v156, v144, v145
    v_mfma_f32_16x16x32_bf16 v[108:111], a[52:55], v[60:63], v[108:111]
    v_cvt_pk_bf16_f32 v157, v146, v147
    v_min_u32 v156, -2, v156
    v_mfma_f32_16x16x32_bf16 v[108:111], a[56:59], v[64:67], v[108:111]
    buffer_load_dwordx4 v38, s[52:55], s83 offen offset:3072 lds
    ds_read_b64_tr_b16 v[228:229], v7 offset:32768
    v_pk_fma_f32 v[144:145], v[136:137], v[128:129], v[112:113] op_sel_hi:[0,1,1]
    v_pk_fma_f32 v[146:147], v[136:137], v[130:131], v[114:115] op_sel_hi:[0,1,1]
    v_pk_fma_f32 v[148:149], v[136:137], v[132:133], v[116:117] op_sel_hi:[0,1,1]
    v_pk_fma_f32 v[150:151], v[136:137], v[134:135], v[118:119] op_sel_hi:[0,1,1]
    v_pk_mul_f32 v[152:153], v[144:145], v[144:145]
    v_pk_mul_f32 v[154:155], v[146:147], v[146:147]
    v_pk_fma_f32 v[152:153], v[152:153], v[138:139], v[136:137] op_sel:[0,0,1] op_sel_hi:[1,0,1]
    v_pk_fma_f32 v[154:155], v[154:155], v[138:139], v[136:137] op_sel:[0,0,1] op_sel_hi:[1,0,1]
    v_pk_mul_f32 v[152:153], v[152:153], v[144:145]
    v_pk_mul_f32 v[154:155], v[154:155], v[146:147]
    v_mfma_f32_16x16x32_bf16 v[108:111], a[60:63], v[68:71], v[108:111]
    ds_read_b64_tr_b16 v[230:231], v7 offset:34816
    ds_read_b64_tr_b16 v[232:233], v10 offset:32768
    ds_read_b64_tr_b16 v[234:235], v10 offset:34816
    ds_read_b64_tr_b16 v[236:237], v13 offset:32768
    ds_read_b64_tr_b16 v[238:239], v13 offset:34816
    ds_read_b64_tr_b16 v[224:225], v4 offset:32768
    ds_read_b64_tr_b16 v[226:227], v4 offset:34816
    v_mfma_f32_16x16x32_bf16 v[108:111], a[160:163], v[72:75], v[108:111]
    s_add_u32 m0, s85, 32768
    ds_read_b128 v[140:143], v22 offset:1280
    v_mfma_f32_16x16x32_bf16 v[108:111], a[164:167], v[76:79], v[108:111]
    s_add_u32 s83, s47, 360448
    v_exp_f32 v152, v152
    v_mfma_f32_16x16x32_bf16 v[108:111], a[168:171], v[80:83], v[108:111]
    s_waitcnt vmcnt(8) lgkmcnt(1)
    buffer_load_dwordx4 v35, s[52:55], s83 offen offset:0 lds
    buffer_store_dword v39, off, s[40:43], s77 offset:256 sc1
    v_mfma_f32_16x16x32_bf16 v[108:111], a[172:175], v[84:87], v[108:111]
    v_exp_f32 v153, v153
    v_mfma_f32_16x16x32_bf16 v[108:111], a[176:179], v[88:91], v[108:111]
    v_exp_f32 v154, v154
    v_mfma_f32_16x16x32_bf16 v[108:111], a[180:183], v[92:95], v[108:111]
    v_exp_f32 v155, v155
    v_mfma_f32_16x16x32_bf16 v[108:111], a[184:187], v[96:99], v[108:111]
    buffer_load_dwordx4 v36, s[52:55], s83 offen offset:1024 lds
    v_mul_f32 v144, v144, v148
    v_mfma_f32_16x16x32_bf16 v[108:111], a[188:191], v[100:103], v[108:111]
    v_mul_f32 v145, v145, v149
    v_mul_f32 v146, v146, v150
    v_mfma_f32_16x16x32_bf16 v[112:115], a[64:67], v[40:43], 0
    v_mul_f32 v147, v147, v151
    v_fma_f32 v152, v152, v139, v139
    v_mfma_f32_16x16x32_bf16 v[112:115], a[68:71], v[44:47], v[112:115]
    v_fma_f32 v153, v153, v139, v139
    v_fma_f32 v154, v154, v139, v139
    v_mfma_f32_16x16x32_bf16 v[112:115], a[72:75], v[48:51], v[112:115]
    buffer_load_dwordx4 v37, s[52:55], s83 offen offset:2048 lds
    v_fma_f32 v155, v155, v139, v139
    v_mfma_f32_16x16x32_bf16 v[112:115], a[76:79], v[52:55], v[112:115]
    v_rcp_f32 v152, v152
    v_mfma_f32_16x16x32_bf16 v[112:115], a[80:83], v[56:59], v[112:115]
    v_rcp_f32 v153, v153
    v_mfma_f32_16x16x32_bf16 v[112:115], a[84:87], v[60:63], v[112:115]
    v_rcp_f32 v154, v154
    v_mfma_f32_16x16x32_bf16 v[112:115], a[88:91], v[64:67], v[112:115]
    buffer_load_dwordx4 v38, s[52:55], s83 offen offset:3072 lds
    v_mfma_f32_16x16x32_bf16 v[112:115], a[92:95], v[68:71], v[112:115]
    s_add_u32 s83, s86, 0
    v_rcp_f32 v155, v155
    v_mfma_f32_16x16x32_bf16 v[112:115], a[192:195], v[72:75], v[112:115]
    v_mul_f32 v144, v144, v152
    v_mul_f32 v145, v145, v153
    v_mfma_f32_16x16x32_bf16 v[112:115], a[196:199], v[76:79], v[112:115]
    v_mul_f32 v146, v146, v154
    v_mul_f32 v147, v147, v155
    v_mfma_f32_16x16x32_bf16 v[112:115], a[200:203], v[80:83], v[112:115]
    buffer_load_dwordx2 v[16:17], v25, s[60:63], s83 offen sc1
    v_cvt_pk_bf16_f32 v158, v144, v145
    v_mfma_f32_16x16x32_bf16 v[112:115], a[204:207], v[84:87], v[112:115]
    s_add_u32 s83, s86, 32768
    v_cvt_pk_bf16_f32 v159, v146, v147
    v_mfma_f32_16x16x32_bf16 v[112:115], a[208:211], v[88:91], v[112:115]
    buffer_store_dwordx4 v[156:159], v1, s[40:43], s76 offen sc1
    v_mfma_f32_16x16x32_bf16 v[112:115], a[212:215], v[92:95], v[112:115]
    s_waitcnt lgkmcnt(0)
    v_fma_f32 v144, v140, v120, v104
    v_fma_f32 v145, v140, v121, v105
    v_mfma_f32_16x16x32_bf16 v[112:115], a[216:219], v[96:99], v[112:115]
    buffer_load_dwordx2 v[18:19], v25, s[60:63], s83 offen sc1
    v_fma_f32 v146, v140, v122, v106
    v_mfma_f32_16x16x32_bf16 v[112:115], a[220:223], v[100:103], v[112:115]
    s_add_u32 s83, s86, 65536
    v_fma_f32 v147, v140, v123, v107
    v_fma_f32 v148, v140, v124, v108
    v_mfma_f32_16x16x32_bf16 v[116:119], a[96:99], v[40:43], 0
    ds_read_b128 v[40:43], v21 offset:32768
    v_fma_f32 v149, v140, v125, v109
    v_mfma_f32_16x16x32_bf16 v[116:119], a[100:103], v[44:47], v[116:119]
    ds_read_b128 v[44:47], v21 offset:33792
    v_fma_f32 v150, v140, v126, v110
    v_mfma_f32_16x16x32_bf16 v[116:119], a[104:107], v[48:51], v[116:119]
    ds_read_b128 v[48:51], v21 offset:34816
    buffer_load_dwordx2 v[26:27], v25, s[60:63], s83 offen sc1
    v_mfma_f32_16x16x32_bf16 v[116:119], a[108:111], v[52:55], v[116:119]
    ds_read_b128 v[52:55], v21 offset:35840
    v_fma_f32 v151, v140, v127, v111
    v_mfma_f32_16x16x32_bf16 v[116:119], a[112:115], v[56:59], v[116:119]
    ds_read_b128 v[56:59], v21 offset:36864
    v_mul_f32 v152, v144, v144
    v_mfma_f32_16x16x32_bf16 v[116:119], a[116:119], v[60:63], v[116:119]
    ds_read_b128 v[60:63], v21 offset:37888
    v_mul_f32 v153, v145, v145
    v_mfma_f32_16x16x32_bf16 v[116:119], a[120:123], v[64:67], v[116:119]
    ds_read_b128 v[64:67], v21 offset:38912
    buffer_load_dwordx2 v[28:29], v1, s[60:63], s66 offen sc1
    v_mfma_f32_16x16x32_bf16 v[116:119], a[124:127], v[68:71], v[116:119]
    ds_read_b128 v[68:71], v21 offset:39936
    v_mul_f32 v154, v146, v146
    v_mfma_f32_16x16x32_bf16 v[116:119], a[224:227], v[72:75], v[116:119]
    ds_read_b128 v[72:75], v21 offset:40960
    v_mul_f32 v155, v147, v147
    v_mfma_f32_16x16x32_bf16 v[116:119], a[228:231], v[76:79], v[116:119]
    ds_read_b128 v[76:79], v21 offset:41984
    v_fma_f32 v152, v152, v142, v141
    v_mfma_f32_16x16x32_bf16 v[116:119], a[232:235], v[80:83], v[116:119]
    ds_read_b128 v[80:83], v21 offset:43008
    buffer_load_dword v24, v23, s[60:63], s79 offen offset:0 sc1
    v_mfma_f32_16x16x32_bf16 v[116:119], a[236:239], v[84:87], v[116:119]
    ds_read_b128 v[84:87], v21 offset:44032
    v_fma_f32 v153, v153, v142, v141
    v_mfma_f32_16x16x32_bf16 v[116:119], a[240:243], v[88:91], v[116:119]
    ds_read_b128 v[88:91], v21 offset:45056
    v_fma_f32 v154, v154, v142, v141
    v_mfma_f32_16x16x32_bf16 v[116:119], a[244:247], v[92:95], v[116:119]
    ds_read_b128 v[92:95], v21 offset:46080
    v_fma_f32 v155, v155, v142, v141
    v_mfma_f32_16x16x32_bf16 v[116:119], a[248:251], v[96:99], v[116:119]
    ds_read_b128 v[96:99], v21 offset:47104
    v_mul_f32 v152, v152, v144
    v_mfma_f32_16x16x32_bf16 v[116:119], a[252:255], v[100:103], v[116:119]
    s_waitcnt lgkmcnt(11)
    ds_read_b128 v[100:103], v21 offset:48128
    v_mul_f32 v153, v153, v145
    v_mfma_f32_16x16x32_bf16 v[104:107], a[0:3], v[40:43], 0
    s_waitcnt vmcnt(15)
    ds_read2st64_b32 v[30:31], v3 offset0:192 offset1:196
    ds_read2st64_b32 v[32:33], v3 offset0:200 offset1:204
    v_mfma_f32_16x16x32_bf16 v[104:107], a[4:7], v[44:47], v[104:107]
    s_add_u32 s76, s75, 286720
    v_mul_f32 v154, v154, v146
    v_mul_f32 v155, v155, v147
    v_mfma_f32_16x16x32_bf16 v[104:107], a[8:11], v[48:51], v[104:107]
    v_exp_f32 v152, v152
    v_mfma_f32_16x16x32_bf16 v[104:107], a[12:15], v[52:55], v[104:107]
    s_waitcnt lgkmcnt(10)
    v_exp_f32 v153, v153
    v_mfma_f32_16x16x32_bf16 v[104:107], a[16:19], v[56:59], v[104:107]
    v_exp_f32 v154, v154
    v_mfma_f32_16x16x32_bf16 v[104:107], a[20:23], v[60:63], v[104:107]
    s_waitcnt lgkmcnt(0)
    v_max3_u32 v30, v30, v31, v32
    v_max_u32 v30, v30, v33
    v_mfma_f32_16x16x32_bf16 v[104:107], a[24:27], v[64:67], v[104:107]
    v_cmp_eq_u32 vcc, -1, v30
    v_exp_f32 v155, v155
    v_mfma_f32_16x16x32_bf16 v[104:107], a[28:31], v[68:71], v[104:107]
    s_add_u32 m0, s85, 98304
    v_mul_f32 v144, v144, v148
    v_mul_f32 v145, v145, v149
    v_mfma_f32_16x16x32_bf16 v[104:107], a[128:131], v[72:75], v[104:107]
    s_cbranch_vccnz LX_h7
LR_h7:
    v_mfma_f32_16x16x32_bf16 v[104:107], a[132:135], v[76:79], v[104:107]
    s_barrier
    v_mul_f32 v146, v146, v150
    v_mfma_f32_16x16x32_bf16 v[104:107], a[136:139], v[80:83], v[104:107]
    s_add_u32 s83, s47, 393216
    buffer_load_dwordx4 v35, s[52:55], s83 offen offset:0 lds
    v_mul_f32 v147, v147, v151
    v_mfma_f32_16x16x32_bf16 v[104:107], a[140:143], v[84:87], v[104:107]
    v_fma_f32 v152, v152, v143, v143
    v_fma_f32 v153, v153, v143, v143
    v_mfma_f32_16x16x32_bf16 v[104:107], a[144:147], v[88:91], v[104:107]
    v_fma_f32 v154, v154, v143, v143
    v_fma_f32 v155, v155, v143, v143
    v_mfma_f32_16x16x32_bf16 v[104:107], a[148:151], v[92:95], v[104:107]
    v_rcp_f32 v152, v152
    v_mfma_f32_16x16x32_bf16 v[104:107], a[152:155], v[96:99], v[104:107]
    buffer_load_dwordx4 v36, s[52:55], s83 offen offset:1024 lds
    ds_read_b64_tr_b16 v[244:245], v9 offset:0
    v_mfma_f32_16x16x32_bf16 v[104:107], a[156:159], v[100:103], v[104:107]
    v_rcp_f32 v153, v153
    v_mfma_f32_16x16x32_bf16 v[108:111], a[32:35], v[40:43], 0
    v_rcp_f32 v154, v154
    v_mfma_f32_16x16x32_bf16 v[108:111], a[36:39], v[44:47], v[108:111]
    v_rcp_f32 v155, v155
    v_mfma_f32_16x16x32_bf16 v[108:111], a[40:43], v[48:51], v[108:111]
    buffer_load_dwordx4 v37, s[52:55], s83 offen offset:2048 lds
    v_mul_f32 v144, v144, v152
    v_mfma_f32_16x16x32_bf16 v[108:111], a[44:47], v[52:55], v[108:111]
    v_mul_f32 v145, v145, v153
    v_mul_f32 v146, v146, v154
    v_mfma_f32_16x16x32_bf16 v[108:111], a[48:51], v[56:59], v[108:111]
    v_mul_f32 v147, v147, v155
    v_cvt_pk_bf16_f32 v156, v144, v145
    v_mfma_f32_16x16x32_bf16 v[108:111], a[52:55], v[60:63], v[108:111]
    v_cvt_pk_bf16_f32 v157, v146, v147
    v_min_u32 v156, -2, v156
    v_mfma_f32_16x16x32_bf16 v[108:111], a[56:59], v[64:67], v[108:111]
    buffer_load_dwordx4 v38, s[52:55], s83 offen offset:3072 lds
    ds_read_b64_tr_b16 v[246:247], v9 offset:2048
    v_pk_fma_f32 v[144:145], v[140:141], v[128:129], v[112:113] op_sel_hi:[0,1,1]
    v_pk_fma_f32 v[146:147], v[140:141], v[130:131], v[114:115] op_sel_hi:[0,1,1]
    v_pk_fma_f32 v[148:149], v[140:141], v[132:133], v[116:117] op_sel_hi:[0,1,1]
    v_pk_fma_f32 v[150:151], v[140:141], v[134:135], v[118:119] op_sel_hi:[0,1,1]
    v_pk_mul_f32 v[152:153], v[144:145], v[144:145]
    v_pk_mul_f32 v[154:155], v[146:147], v[146:147]
    v_pk_fma_f32 v[152:153], v[152:153], v[142:143], v[140:141] op_sel:[0,0,1] op_sel_hi:[1,0,1]
    v_pk_fma_f32 v[154:155], v[154:155], v[142:143], v[140:141] op_sel:[0,0,1] op_sel_hi:[1,0,1]
    v_pk_mul_f32 v[152:153], v[152:153], v[144:145]
    v_pk_mul_f32 v[154:155], v[154:155], v[146:147]
    v_mfma_f32_16x16x32_bf16 v[108:111], a[60:63], v[68:71], v[108:111]
    ds_read_b64_tr_b16 v[248:249], v12 offset:0
    ds_read_b64_tr_b16 v[250:251], v12 offset:2048
    ds_read_b64_tr_b16 v[252:253], v15 offset:0
    ds_read_b64_tr_b16 v[254:255], v15 offset:2048
    ds_read_b64_tr_b16 v[240:241], v6 offset:0
    ds_read_b64_tr_b16 v[242:243], v6 offset:2048
    v_mfma_f32_16x16x32_bf16 v[108:111], a[160:163], v[72:75], v[108:111]
    s_add_u32 m0, s85, 131072
    ds_read_b128 v[136:139], v22 offset:1536
    v_mfma_f32_16x16x32_bf16 v[108:111], a[164:167], v[76:79], v[108:111]
    s_add_u32 s83, s47, 425984
    v_exp_f32 v152, v152
    v_mfma_f32_16x16x32_bf16 v[108:111], a[168:171], v[80:83], v[108:111]
    s_waitcnt lgkmcnt(1)
    buffer_load_dwordx4 v35, s[52:55], s83 offen offset:0 lds
    v_mfma_f32_16x16x32_bf16 v[108:111], a[172:175], v[84:87], v[108:111]
    v_exp_f32 v153, v153
    v_mfma_f32_16x16x32_bf16 v[108:111], a[176:179], v[88:91], v[108:111]
    v_exp_f32 v154, v154
    v_mfma_f32_16x16x32_bf16 v[108:111], a[180:183], v[92:95], v[108:111]
    v_exp_f32 v155, v155
    v_mfma_f32_16x16x32_bf16 v[108:111], a[184:187], v[96:99], v[108:111]
    buffer_load_dwordx4 v36, s[52:55], s83 offen offset:1024 lds
    v_mul_f32 v144, v144, v148
    v_mfma_f32_16x16x32_bf16 v[108:111], a[188:191], v[100:103], v[108:111]
    v_mul_f32 v145, v145, v149
    v_mul_f32 v146, v146, v150
    v_mfma_f32_16x16x32_bf16 v[112:115], a[64:67], v[40:43], 0
    v_mul_f32 v147, v147, v151
    v_fma_f32 v152, v152, v143, v143
    v_mfma_f32_16x16x32_bf16 v[112:115], a[68:71], v[44:47], v[112:115]
    v_fma_f32 v153, v153, v143, v143
    v_fma_f32 v154, v154, v143, v143
    v_mfma_f32_16x16x32_bf16 v[112:115], a[72:75], v[48:51], v[112:115]
    buffer_load_dwordx4 v37, s[52:55], s83 offen offset:2048 lds
    v_fma_f32 v155, v155, v143, v143
    v_mfma_f32_16x16x32_bf16 v[112:115], a[76:79], v[52:55], v[112:115]
    v_rcp_f32 v152, v152
    v_mfma_f32_16x16x32_bf16 v[112:115], a[80:83], v[56:59], v[112:115]
    v_rcp_f32 v153, v153
    v_mfma_f32_16x16x32_bf16 v[112:115], a[84:87], v[60:63], v[112:115]
    v_rcp_f32 v154, v154
    v_mfma_f32_16x16x32_bf16 v[112:115], a[88:91], v[64:67], v[112:115]
    buffer_load_dwordx4 v38, s[52:55], s83 offen offset:3072 lds
    v_mfma_f32_16x16x32_bf16 v[112:115], a[92:95], v[68:71], v[112:115]
    v_rcp_f32 v155, v155
    v_mfma_f32_16x16x32_bf16 v[112:115], a[192:195], v[72:75], v[112:115]
    buffer_load_dword v34, v23, s[60:63], s79 offen offset:256 sc1
    v_mul_f32 v144, v144, v152
    v_mfma_f32_16x16x32_bf16 v[112:115], a[196:199], v[76:79], v[112:115]
    v_mul_f32 v145, v145, v153
    v_mul_f32 v146, v146, v154
    v_mfma_f32_16x16x32_bf16 v[112:115], a[200:203], v[80:83], v[112:115]
    v_mul_f32 v147, v147, v155
    v_cvt_pk_bf16_f32 v158, v144, v145
    v_mfma_f32_16x16x32_bf16 v[112:115], a[204:207], v[84:87], v[112:115]
    v_cvt_pk_bf16_f32 v159, v146, v147
    v_mfma_f32_16x16x32_bf16 v[112:115], a[208:211], v[88:91], v[112:115]
    buffer_store_dwordx4 v[156:159], v1, s[40:43], s76 offen sc1
    v_mfma_f32_16x16x32_bf16 v[112:115], a[212:215], v[92:95], v[112:115]
    s_waitcnt lgkmcnt(0)
    v_fma_f32 v144, v136, v120, v104
    v_fma_f32 v145, v136, v121, v105
    v_mfma_f32_16x16x32_bf16 v[112:115], a[216:219], v[96:99], v[112:115]
    v_fma_f32 v146, v136, v122, v106
    v_fma_f32 v147, v136, v123, v107
    v_mfma_f32_16x16x32_bf16 v[112:115], a[220:223], v[100:103], v[112:115]
    v_fma_f32 v148, v136, v124, v108
    v_fma_f32 v149, v136, v125, v109
    v_mfma_f32_16x16x32_bf16 v[116:119], a[96:99], v[40:43], 0
    ds_read_b128 v[40:43], v21 offset:49152
    v_fma_f32 v150, v136, v126, v110
    v_mfma_f32_16x16x32_bf16 v[116:119], a[100:103], v[44:47], v[116:119]
    ds_read_b128 v[44:47], v21 offset:50176
    v_fma_f32 v151, v136, v127, v111
    v_mfma_f32_16x16x32_bf16 v[116:119], a[104:107], v[48:51], v[116:119]
    ds_read_b128 v[48:51], v21 offset:51200
    v_mul_f32 v152, v144, v144
    v_mfma_f32_16x16x32_bf16 v[116:119], a[108:111], v[52:55], v[116:119]
    ds_read_b128 v[52:55], v21 offset:52224
    v_mul_f32 v153, v145, v145
    v_mfma_f32_16x16x32_bf16 v[116:119], a[112:115], v[56:59], v[116:119]
    ds_read_b128 v[56:59], v21 offset:53248
    v_mul_f32 v154, v146, v146
    v_mfma_f32_16x16x32_bf16 v[116:119], a[116:119], v[60:63], v[116:119]
    ds_read_b128 v[60:63], v21 offset:54272
    v_mul_f32 v155, v147, v147
    v_mfma_f32_16x16x32_bf16 v[116:119], a[120:123], v[64:67], v[116:119]
    ds_read_b128 v[64:67], v21 offset:55296
    v_fma_f32 v152, v152, v138, v137
    v_mfma_f32_16x16x32_bf16 v[116:119], a[124:127], v[68:71], v[116:119]
    ds_read_b128 v[68:71], v21 offset:56320
    v_fma_f32 v153, v153, v138, v137
    v_mfma_f32_16x16x32_bf16 v[116:119], a[224:227], v[72:75], v[116:119]
    ds_read_b128 v[72:75], v21 offset:57344
    v_fma_f32 v154, v154, v138, v137
    v_mfma_f32_16x16x32_bf16 v[116:119], a[228:231], v[76:79], v[116:119]
    ds_read_b128 v[76:79], v21 offset:58368
    v_fma_f32 v155, v155, v138, v137
    v_mfma_f32_16x16x32_bf16 v[116:119], a[232:235], v[80:83], v[116:119]
    ds_read_b128 v[80:83], v21 offset:59392
    v_mul_f32 v152, v152, v144
    v_mfma_f32_16x16x32_bf16 v[116:119], a[236:239], v[84:87], v[116:119]
    ds_read_b128 v[84:87], v21 offset:60416
    v_mul_f32 v153, v153, v145
    v_mfma_f32_16x16x32_bf16 v[116:119], a[240:243], v[88:91], v[116:119]
    ds_read_b128 v[88:91], v21 offset:61440
    v_mul_f32 v154, v154, v146
    v_mfma_f32_16x16x32_bf16 v[116:119], a[244:247], v[92:95], v[116:119]
    ds_read_b128 v[92:95], v21 offset:62464
    v_mul_f32 v155, v155, v147
    v_mfma_f32_16x16x32_bf16 v[116:119], a[248:251], v[96:99], v[116:119]
    ds_read_b128 v[96:99], v21 offset:63488
    v_mfma_f32_16x16x32_bf16 v[116:119], a[252:255], v[100:103], v[116:119]
    s_waitcnt lgkmcnt(11)
    ds_read_b128 v[100:103], v21 offset:64512
    v_mfma_f32_16x16x32_bf16 v[104:107], a[0:3], v[40:43], 0
    s_add_u32 s76, s75, 344064
    v_exp_f32 v152, v152
    v_mfma_f32_16x16x32_bf16 v[104:107], a[4:7], v[44:47], v[104:107]
    s_waitcnt vmcnt(10)
    v_cmp_gt_u32 vcc, 1, v24
    v_mfma_f32_16x16x32_bf16 v[104:107], a[8:11], v[48:51], v[104:107]
    v_exp_f32 v153, v153
    v_mfma_f32_16x16x32_bf16 v[104:107], a[12:15], v[52:55], v[104:107]
    s_waitcnt lgkmcnt(8)
    s_cbranch_vccnz LX_p1
LR_p1:
    v_mfma_f32_16x16x32_bf16 v[104:107], a[16:19], v[56:59], v[104:107]
    s_add_u32 s70, s82, 0
    buffer_load_dwordx4 a[0:3], v1, s[60:63], s70 offen offset:0 sc1
    ds_read_b128 v[140:143], v22 offset:1792
    v_mfma_f32_16x16x32_bf16 v[104:107], a[20:23], v[60:63], v[104:107]
    v_exp_f32 v154, v154
    v_mfma_f32_16x16x32_bf16 v[104:107], a[24:27], v[64:67], v[104:107]
    v_exp_f32 v155, v155
    v_mfma_f32_16x16x32_bf16 v[104:107], a[28:31], v[68:71], v[104:107]
    s_waitcnt lgkmcnt(5)
    v_mul_f32 v144, v144, v148
    v_mul_f32 v145, v145, v149
    v_mfma_f32_16x16x32_bf16 v[104:107], a[128:131], v[72:75], v[104:107]
    buffer_load_dwordx4 a[4:7], v1, s[60:63], s70 offen offset:1024 sc1
    v_mul_f32 v146, v146, v150
    v_mfma_f32_16x16x32_bf16 v[104:107], a[132:135], v[76:79], v[104:107]
    v_mul_f32 v147, v147, v151
    v_fma_f32 v152, v152, v139, v139
    v_mfma_f32_16x16x32_bf16 v[104:107], a[136:139], v[80:83], v[104:107]
    v_fma_f32 v153, v153, v139, v139
    v_fma_f32 v154, v154, v139, v139
    v_mfma_f32_16x16x32_bf16 v[104:107], a[140:143], v[84:87], v[104:107]
    s_waitcnt lgkmcnt(1)
    v_fma_f32 v155, v155, v139, v139
    v_mfma_f32_16x16x32_bf16 v[104:107], a[144:147], v[88:91], v[104:107]
    buffer_load_dwordx4 a[8:11], v1, s[60:63], s70 offen offset:2048 sc1
    v_mfma_f32_16x16x32_bf16 v[104:107], a[148:151], v[92:95], v[104:107]
    v_rcp_f32 v152, v152
    v_mfma_f32_16x16x32_bf16 v[104:107], a[152:155], v[96:99], v[104:107]
    v_rcp_f32 v153, v153
    v_mfma_f32_16x16x32_bf16 v[104:107], a[156:159], v[100:103], v[104:107]
    v_rcp_f32 v154, v154
    v_mfma_f32_16x16x32_bf16 v[108:111], a[32:35], v[40:43], 0
    buffer_load_dwordx4 a[12:15], v1, s[60:63], s70 offen offset:3072 sc1
    v_mfma_f32_16x16x32_bf16 v[108:111], a[36:39], v[44:47], v[108:111]
    s_add_u32 s70, s82, 4096
    v_rcp_f32 v155, v155
    v_mfma_f32_16x16x32_bf16 v[108:111], a[40:43], v[48:51], v[108:111]
    v_mul_f32 v144, v144, v152
    v_mul_f32 v145, v145, v153
    v_mfma_f32_16x16x32_bf16 v[108:111], a[44:47], v[52:55], v[108:111]
    v_mul_f32 v146, v146, v154
    v_mul_f32 v147, v147, v155
    v_mfma_f32_16x16x32_bf16 v[108:111], a[48:51], v[56:59], v[108:111]
    v_cvt_pk_bf16_f32 v156, v144, v145
    v_cvt_pk_bf16_f32 v157, v146, v147
    v_mfma_f32_16x16x32_bf16 v[108:111], a[52:55], v[60:63], v[108:111]
    buffer_load_dwordx4 a[16:19], v1, s[60:63], s70 offen offset:0 sc1
    v_min_u32 v156, -2, v156
    v_mfma_f32_16x16x32_bf16 v[108:111], a[56:59], v[64:67], v[108:111]
    v_pk_fma_f32 v[144:145], v[136:137], v[128:129], v[112:113] op_sel_hi:[0,1,1]
    v_pk_fma_f32 v[146:147], v[136:137], v[130:131], v[114:115] op_sel_hi:[0,1,1]
    v_pk_fma_f32 v[148:149], v[136:137], v[132:133], v[116:117] op_sel_hi:[0,1,1]
    v_pk_fma_f32 v[150:151], v[136:137], v[134:135], v[118:119] op_sel_hi:[0,1,1]
    v_pk_mul_f32 v[152:153], v[144:145], v[144:145]
    v_pk_mul_f32 v[154:155], v[146:147], v[146:147]
    v_pk_fma_f32 v[152:153], v[152:153], v[138:139], v[136:137] op_sel:[0,0,1] op_sel_hi:[1,0,1]
    v_pk_fma_f32 v[154:155], v[154:155], v[138:139], v[136:137] op_sel:[0,0,1] op_sel_hi:[1,0,1]
    v_pk_mul_f32 v[152:153], v[152:153], v[144:145]
    v_pk_mul_f32 v[154:155], v[154:155], v[146:147]
    v_mfma_f32_16x16x32_bf16 v[108:111], a[60:63], v[68:71], v[108:111]
    v_exp_f32 v152, v152
    v_mfma_f32_16x16x32_bf16 v[108:111], a[160:163], v[72:75], v[108:111]
    buffer_load_dwordx4 a[20:23], v1, s[60:63], s70 offen offset:1024 sc1
    v_mfma_f32_16x16x32_bf16 v[108:111], a[164:167], v[76:79], v[108:111]
    v_exp_f32 v153, v153
    v_mfma_f32_16x16x32_bf16 v[108:111], a[168:171], v[80:83], v[108:111]
    v_exp_f32 v154, v154
    v_mfma_f32_16x16x32_bf16 v[108:111], a[172:175], v[84:87], v[108:111]
    v_exp_f32 v155, v155
    v_mfma_f32_16x16x32_bf16 v[108:111], a[176:179], v[88:91], v[108:111]
    buffer_load_dwordx4 a[24:27], v1, s[60:63], s70 offen offset:2048 sc1
    v_mul_f32 v144, v144, v148
    v_mfma_f32_16x16x32_bf16 v[108:111], a[180:183], v[92:95], v[108:111]
    v_mul_f32 v145, v145, v149
    v_mul_f32 v146, v146, v150
    v_mfma_f32_16x16x32_bf16 v[108:111], a[184:187], v[96:99], v[108:111]
    v_mul_f32 v147, v147, v151
    v_fma_f32 v152, v152, v139, v139
    v_mfma_f32_16x16x32_bf16 v[108:111], a[188:191], v[100:103], v[108:111]
    v_fma_f32 v153, v153, v139, v139
    v_fma_f32 v154, v154, v139, v139
    v_mfma_f32_16x16x32_bf16 v[112:115], a[64:67], v[40:43], 0
    buffer_load_dwordx4 a[28:31], v1, s[60:63], s70 offen offset:3072 sc1
    v_fma_f32 v155, v155, v139, v139
    v_mfma_f32_16x16x32_bf16 v[112:115], a[68:71], v[44:47], v[112:115]
    s_add_u32 s70, s82, 8192
    v_rcp_f32 v152, v152
    v_mfma_f32_16x16x32_bf16 v[112:115], a[72:75], v[48:51], v[112:115]
    v_rcp_f32 v153, v153
    v_mfma_f32_16x16x32_bf16 v[112:115], a[76:79], v[52:55], v[112:115]
    v_rcp_f32 v154, v154
    v_mfma_f32_16x16x32_bf16 v[112:115], a[80:83], v[56:59], v[112:115]
    buffer_load_dwordx4 a[128:131], v1, s[60:63], s70 offen offset:0 sc1
    v_mfma_f32_16x16x32_bf16 v[112:115], a[84:87], v[60:63], v[112:115]
    s_waitcnt vmcnt(10)
    v_cmp_gt_u32 vcc, 1, v34
    v_mfma_f32_16x16x32_bf16 v[112:115], a[88:91], v[64:67], v[112:115]
    v_rcp_f32 v155, v155
    v_mfma_f32_16x16x32_bf16 v[112:115], a[92:95], v[68:71], v[112:115]
    s_cbranch_vccnz LX_p2
LR_p2:
    v_mfma_f32_16x16x32_bf16 v[112:115], a[192:195], v[72:75], v[112:115]
    s_add_u32 s70, s82, 114688
    buffer_load_dwordx4 a[32:35], v1, s[60:63], s70 offen offset:0 sc1
    v_mul_f32 v144, v144, v152
    v_mfma_f32_16x16x32_bf16 v[112:115], a[196:199], v[76:79], v[112:115]
    v_mul_f32 v145, v145, v153
    v_mul_f32 v146, v146, v154
    v_mfma_f32_16x16x32_bf16 v[112:115], a[200:203], v[80:83], v[112:115]
    v_mul_f32 v147, v147, v155
    v_cvt_pk_bf16_f32 v158, v144, v145
    v_mfma_f32_16x16x32_bf16 v[112:115], a[204:207], v[84:87], v[112:115]
    v_cvt_pk_bf16_f32 v159, v146, v147
    v_mfma_f32_16x16x32_bf16 v[112:115], a[208:211], v[88:91], v[112:115]
    buffer_load_dwordx4 a[36:39], v1, s[60:63], s70 offen offset:1024 sc1
    buffer_store_dwordx4 v[156:159], v1, s[40:43], s76 offen sc1
    v_mfma_f32_16x16x32_bf16 v[112:115], a[212:215], v[92:95], v[112:115]
    s_waitcnt lgkmcnt(0)
    v_fma_f32 v144, v140, v120, v104
    v_fma_f32 v145, v140, v121, v105
    v_mfma_f32_16x16x32_bf16 v[112:115], a[216:219], v[96:99], v[112:115]
Lpad_est2:
Lpad_7:
    s_cbranch_execz Lpad_retst
    v_fma_f32 v146, v140, v122, v106
    v_fma_f32 v147, v140, v123, v107
    v_mfma_f32_16x16x32_bf16 v[112:115], a[220:223], v[100:103], v[112:115]
    v_fma_f32 v148, v140, v124, v108
    v_fma_f32 v149, v140, v125, v109
    v_mfma_f32_16x16x32_bf16 v[116:119], a[96:99], v[40:43], 0
    buffer_load_dwordx4 a[40:43], v1, s[60:63], s70 offen offset:2048 sc1
    v_fma_f32 v150, v140, v126, v110
    v_mfma_f32_16x16x32_bf16 v[116:119], a[100:103], v[44:47], v[116:119]
    v_fma_f32 v151, v140, v127, v111
    v_mul_f32 v152, v144, v144
    v_mfma_f32_16x16x32_bf16 v[116:119], a[104:107], v[48:51], v[116:119]
    v_mul_f32 v153, v145, v145
    v_mul_f32 v154, v146, v146
    v_mfma_f32_16x16x32_bf16 v[116:119], a[108:111], v[52:55], v[116:119]
    v_mul_f32 v155, v147, v147
    v_fma_f32 v152, v152, v142, v141
    v_mfma_f32_16x16x32_bf16 v[116:119], a[112:115], v[56:59], v[116:119]
    buffer_load_dwordx4 a[44:47], v1, s[60:63], s70 offen offset:3072 sc1
    v_fma_f32 v153, v153, v142, v141
    v_mfma_f32_16x16x32_bf16 v[116:119], a[116:119], v[60:63], v[116:119]
    s_add_u32 s70, s82, 118784
    v_fma_f32 v154, v154, v142, v141
    v_fma_f32 v155, v155, v142, v141
    v_mfma_f32_16x16x32_bf16 v[116:119], a[120:123], v[64:67], v[116:119]
    v_mul_f32 v152, v152, v144
    v_mul_f32 v153, v153, v145
    v_mfma_f32_16x16x32_bf16 v[116:119], a[124:127], v[68:71], v[116:119]
    v_mul_f32 v154, v154, v146
    v_mul_f32 v155, v155, v147
    v_mfma_f32_16x16x32_bf16 v[116:119], a[224:227], v[72:75], v[116:119]
    buffer_load_dwordx4 a[48:51], v1, s[60:63], s70 offen offset:0 sc1
    v_exp_f32 v152, v152
    v_mfma_f32_16x16x32_bf16 v[116:119], a[228:231], v[76:79], v[116:119]
    v_exp_f32 v153, v153
    v_mfma_f32_16x16x32_bf16 v[116:119], a[232:235], v[80:83], v[116:119]
    v_exp_f32 v154, v154
    v_mfma_f32_16x16x32_bf16 v[116:119], a[236:239], v[84:87], v[116:119]
    v_exp_f32 v155, v155
    v_mfma_f32_16x16x32_bf16 v[116:119], a[240:243], v[88:91], v[116:119]
    buffer_load_dwordx4 a[52:55], v1, s[60:63], s70 offen offset:1024 sc1
    v_mul_f32 v144, v144, v148
    v_mfma_f32_16x16x32_bf16 v[116:119], a[244:247], v[92:95], v[116:119]
    v_mul_f32 v145, v145, v149
    v_mul_f32 v146, v146, v150
    v_mfma_f32_16x16x32_bf16 v[116:119], a[248:251], v[96:99], v[116:119]
    v_mul_f32 v147, v147, v151
    v_fma_f32 v152, v152, v143, v143
    v_mfma_f32_16x16x32_bf16 v[116:119], a[252:255], v[100:103], v[116:119]
    v_fma_f32 v153, v153, v143, v143
    v_fma_f32 v154, v154, v143, v143
LD_start:
    s_waitcnt vmcnt(15)
    v_mfma_f32_16x16x32_bf16 v[108:111], a[0:3], v[164:167], 0
    s_add_u32 s70, s82, 8192
    buffer_load_dwordx4 a[132:135], v1, s[60:63], s70 offen offset:1024 sc1
    v_fma_f32 v155, v155, v143, v143
    v_mfma_f32_16x16x32_bf16 v[120:123], a[0:3], v[168:171], 0
    s_add_u32 s76, s75, 401408
    v_rcp_f32 v152, v152
    v_mfma_f32_16x16x32_bf16 v[124:127], a[0:3], v[172:175], 0
    v_rcp_f32 v153, v153
    v_mfma_f32_16x16x32_bf16 v[104:107], a[0:3], v[160:163], 0
    s_waitcnt vmcnt(15)
    v_rcp_f32 v154, v154
    v_mfma_f32_16x16x32_bf16 v[108:111], a[4:7], v[180:183], v[108:111]
    v_rcp_f32 v155, v155
    v_mfma_f32_16x16x32_bf16 v[120:123], a[4:7], v[184:187], v[120:123]
    buffer_load_dwordx4 a[136:139], v1, s[60:63], s70 offen offset:2048 sc1
    v_mul_f32 v144, v144, v152
    v_mfma_f32_16x16x32_bf16 v[124:127], a[4:7], v[188:191], v[124:127]
    v_mul_f32 v145, v145, v153
    v_mul_f32 v146, v146, v154
    v_mfma_f32_16x16x32_bf16 v[104:107], a[4:7], v[176:179], v[104:107]
    s_waitcnt vmcnt(15)
    v_mul_f32 v147, v147, v155
    v_cvt_pk_bf16_f32 v156, v144, v145
    v_mfma_f32_16x16x32_bf16 v[108:111], a[8:11], v[196:199], v[108:111]
    v_cvt_pk_bf16_f32 v157, v146, v147
    v_min_u32 v156, -2, v156
    v_mfma_f32_16x16x32_bf16 v[120:123], a[8:11], v[200:203], v[120:123]
    v_fma_f32 v144, v140, v128, v112
    v_fma_f32 v145, v140, v129, v113
    v_mfma_f32_16x16x32_bf16 v[124:127], a[8:11], v[204:207], v[124:127]
    buffer_load_dwordx4 a[140:143], v1, s[60:63], s70 offen offset:3072 sc1
    v_fma_f32 v146, v140, v130, v114
    v_mfma_f32_16x16x32_bf16 v[104:107], a[8:11], v[192:195], v[104:107]
    s_waitcnt vmcnt(15)
    v_fma_f32 v147, v140, v131, v115
    v_fma_f32 v148, v140, v132, v116
    v_mfma_f32_16x16x32_bf16 v[108:111], a[12:15], v[212:215], v[108:111]
    s_add_u32 s70, s82, 12288
    v_fma_f32 v149, v140, v133, v117
    v_fma_f32 v150, v140, v134, v118
    v_mfma_f32_16x16x32_bf16 v[120:123], a[12:15], v[216:219], v[120:123]
    v_fma_f32 v151, v140, v135, v119
    v_mul_f32 v152, v144, v144
    v_mfma_f32_16x16x32_bf16 v[124:127], a[12:15], v[220:223], v[124:127]
    v_mul_f32 v153, v145, v145
    v_mul_f32 v154, v146, v146
    v_mfma_f32_16x16x32_bf16 v[104:107], a[12:15], v[208:211], v[104:107]
    s_waitcnt vmcnt(14)
    buffer_load_dwordx4 a[144:147], v1, s[60:63], s70 offen offset:0 sc1
    v_mul_f32 v155, v147, v147
    v_mfma_f32_16x16x32_bf16 v[108:111], a[16:19], v[228:231], v[108:111]
    v_fma_f32 v152, v152, v142, v141
    v_fma_f32 v153, v153, v142, v141
    v_mfma_f32_16x16x32_bf16 v[120:123], a[16:19], v[232:235], v[120:123]
    v_fma_f32 v154, v154, v142, v141
    v_fma_f32 v155, v155, v142, v141
    v_mfma_f32_16x16x32_bf16 v[124:127], a[16:19], v[236:239], v[124:127]
    v_mul_f32 v152, v152, v144
    v_mul_f32 v153, v153, v145
    v_mfma_f32_16x16x32_bf16 v[104:107], a[16:19], v[224:227], v[104:107]
    s_waitcnt vmcnt(14)
    v_mul_f32 v154, v154, v146
    v_mul_f32 v155, v155, v147
    v_mfma_f32_16x16x32_bf16 v[108:111], a[20:23], v[244:247], v[108:111]
    buffer_load_dwordx4 a[148:151], v1, s[60:63], s70 offen offset:1024 sc1
    v_exp_f32 v152, v152
    v_mfma_f32_16x16x32_bf16 v[120:123], a[20:23], v[248:251], v[120:123]
    v_exp_f32 v153, v153
    v_mfma_f32_16x16x32_bf16 v[124:127], a[20:23], v[252:255], v[124:127]
    s_add_u32 s70, s82, 118784
    v_exp_f32 v154, v154
    v_mfma_f32_16x16x32_bf16 v[104:107], a[20:23], v[240:243], v[104:107]
    s_waitcnt vmcnt(11)
    v_exp_f32 v155, v155
    v_mfma_f32_16x16x32_bf16 v[116:119], a[32:35], v[164:167], 0
    v_mul_f32 v144, v144, v148
    v_mul_f32 v145, v145, v149
    v_mfma_f32_16x16x32_bf16 v[128:131], a[32:35], v[168:171], 0
    buffer_load_dwordx4 a[56:59], v1, s[60:63], s70 offen offset:2048 sc1
    v_mul_f32 v146, v146, v150
    v_mfma_f32_16x16x32_bf16 v[132:135], a[32:35], v[172:175], 0
    v_mul_f32 v147, v147, v151
    v_fma_f32 v152, v152, v143, v143
    v_mfma_f32_16x16x32_bf16 v[112:115], a[32:35], v[160:163], 0
    s_waitcnt vmcnt(11)
    v_fma_f32 v153, v153, v143, v143
    v_fma_f32 v154, v154, v143, v143
    v_mfma_f32_16x16x32_bf16 v[116:119], a[36:39], v[180:183], v[116:119]
    v_fma_f32 v155, v155, v143, v143
    v_rcp_f32 v152, v152
    v_mfma_f32_16x16x32_bf16 v[128:131], a[36:39], v[184:187], v[128:131]
    v_rcp_f32 v153, v153
    v_mfma_f32_16x16x32_bf16 v[132:135], a[36:39], v[188:191], v[132:135]
    buffer_load_dwordx4 a[60:63], v1, s[60:63], s70 offen offset:3072 sc1
    v_rcp_f32 v154, v154
    v_mfma_f32_16x16x32_bf16 v[112:115], a[36:39], v[176:179], v[112:115]
    s_waitcnt vmcnt(10)
    v_rcp_f32 v155, v155
    v_mfma_f32_16x16x32_bf16 v[116:119], a[40:43], v[196:199], v[116:119]
    s_add_u32 s70, s82, 122880
    v_mul_f32 v144, v144, v152
    v_mul_f32 v145, v145, v153
    v_mfma_f32_16x16x32_bf16 v[128:131], a[40:43], v[200:203], v[128:131]
    v_mul_f32 v146, v146, v154
    v_mul_f32 v147, v147, v155
    v_cvt_pk_bf16_f32 v158, v144, v145
    v_cvt_pk_bf16_f32 v159, v146, v147
    v_mfma_f32_16x16x32_bf16 v[132:135], a[40:43], v[204:207], v[132:135]
    buffer_store_dwordx4 v[156:159], v1, s[40:43], s76 offen sc1
    ds_read_b64_tr_b16 a[68:69], v7 offset:49152
    v_mfma_f32_16x16x32_bf16 v[112:115], a[40:43], v[192:195], v[112:115]
    s_waitcnt vmcnt(10)
    buffer_load_dwordx4 a[160:163], v1, s[60:63], s70 offen offset:0 sc1
    ds_read_b64_tr_b16 a[70:71], v7 offset:51200
    v_mfma_f32_16x16x32_bf16 v[116:119], a[44:47], v[212:215], v[116:119]
    ds_read_b64_tr_b16 a[72:73], v10 offset:49152
    ds_read_b64_tr_b16 a[74:75], v10 offset:51200
    v_mfma_f32_16x16x32_bf16 v[128:131], a[44:47], v[216:219], v[128:131]
    ds_read_b64_tr_b16 a[76:77], v13 offset:49152
    ds_read_b64_tr_b16 a[78:79], v13 offset:51200
    v_mfma_f32_16x16x32_bf16 v[132:135], a[44:47], v[220:223], v[132:135]
    ds_read_b64_tr_b16 a[64:65], v4 offset:49152
    ds_read_b64_tr_b16 a[66:67], v4 offset:51200
    v_mfma_f32_16x16x32_bf16 v[112:115], a[44:47], v[208:211], v[112:115]
    s_waitcnt vmcnt(10)
    ds_read_b64_tr_b16 a[84:85], v7 offset:16384
    ds_read_b64_tr_b16 a[86:87], v7 offset:18432
    v_mfma_f32_16x16x32_bf16 v[116:119], a[48:51], v[228:231], v[116:119]
    buffer_load_dwordx4 a[164:167], v1, s[60:63], s70 offen offset:1024 sc1
    ds_read_b64_tr_b16 a[88:89], v10 offset:16384
    v_mfma_f32_16x16x32_bf16 v[128:131], a[48:51], v[232:235], v[128:131]
    ds_read_b64_tr_b16 a[90:91], v10 offset:18432
    ds_read_b64_tr_b16 a[92:93], v13 offset:16384
    v_mfma_f32_16x16x32_bf16 v[132:135], a[48:51], v[236:239], v[132:135]
    ds_read_b64_tr_b16 a[94:95], v13 offset:18432
    ds_read_b64_tr_b16 a[80:81], v4 offset:16384
    v_mfma_f32_16x16x32_bf16 v[112:115], a[48:51], v[224:227], v[112:115]
    s_waitcnt vmcnt(10)
    ds_read_b64_tr_b16 a[82:83], v4 offset:18432
    ds_read_b64_tr_b16 a[196:197], v8 offset:0
    v_mfma_f32_16x16x32_bf16 v[116:119], a[52:55], v[244:247], v[116:119]
    ds_read_b64_tr_b16 a[198:199], v8 offset:2048
    ds_read_b64_tr_b16 a[200:201], v11 offset:0
    v_mfma_f32_16x16x32_bf16 v[128:131], a[52:55], v[248:251], v[128:131]
    buffer_load_dwordx4 a[168:171], v1, s[60:63], s70 offen offset:2048 sc1
    ds_read_b64_tr_b16 a[202:203], v11 offset:2048
    v_mfma_f32_16x16x32_bf16 v[132:135], a[52:55], v[252:255], v[132:135]
    ds_read_b64_tr_b16 a[204:205], v14 offset:0
    ds_read_b64_tr_b16 a[206:207], v14 offset:2048
    v_mfma_f32_16x16x32_bf16 v[112:115], a[52:55], v[240:243], v[112:115]
    s_waitcnt lgkmcnt(14)
    ds_read_b64_tr_b16 a[192:193], v5 offset:0
    ds_read_b64_tr_b16 a[194:195], v5 offset:2048
    v_mfma_f32_16x16x32_bf16 v[108:111], a[24:27], a[68:71], v[108:111]
    ds_read_b64_tr_b16 a[212:213], v7 offset:0
    ds_read_b64_tr_b16 a[214:215], v7 offset:2048
    v_mfma_f32_16x16x32_bf16 v[120:123], a[24:27], a[72:75], v[120:123]
    ds_read_b64_tr_b16 a[216:217], v10 offset:0
    ds_read_b64_tr_b16 a[218:219], v10 offset:2048
    v_mfma_f32_16x16x32_bf16 v[124:127], a[24:27], a[76:79], v[124:127]
    buffer_load_dwordx4 a[172:175], v1, s[60:63], s70 offen offset:3072 sc1
    ds_read_b64_tr_b16 a[220:221], v13 offset:0
    v_mfma_f32_16x16x32_bf16 v[104:107], a[24:27], a[64:67], v[104:107]
    s_waitcnt lgkmcnt(13)
    ds_read_b64_tr_b16 a[222:223], v13 offset:2048
    ds_read_b64_tr_b16 a[208:209], v4 offset:0
    v_mfma_f32_16x16x32_bf16 v[108:111], a[28:31], a[84:87], v[108:111]
    s_add_u32 s70, s82, 126976
    ds_read_b64_tr_b16 a[210:211], v4 offset:2048
    ds_read_b64_tr_b16 a[100:101], v8 offset:16384
    v_mfma_f32_16x16x32_bf16 v[120:123], a[28:31], a[88:91], v[120:123]
    ds_read_b64_tr_b16 a[102:103], v8 offset:18432
    ds_read_b64_tr_b16 a[104:105], v11 offset:16384
    v_mfma_f32_16x16x32_bf16 v[124:127], a[28:31], a[92:95], v[124:127]
    ds_read_b64_tr_b16 a[106:107], v11 offset:18432
    ds_read_b64_tr_b16 a[108:109], v14 offset:16384
    v_mfma_f32_16x16x32_bf16 v[104:107], a[28:31], a[80:83], v[104:107]
    s_waitcnt lgkmcnt(13)
    buffer_load_dwordx4 a[176:179], v1, s[60:63], s70 offen offset:0 sc1
    ds_read_b64_tr_b16 a[110:111], v14 offset:18432
    v_mfma_f32_16x16x32_bf16 v[108:111], a[128:131], a[196:199], v[108:111]
    ds_read_b64_tr_b16 a[96:97], v5 offset:16384
    ds_read_b64_tr_b16 a[98:99], v5 offset:18432
    v_mfma_f32_16x16x32_bf16 v[120:123], a[128:131], a[200:203], v[120:123]
    ds_read_b64_tr_b16 a[116:117], v7 offset:32768
    ds_read_b64_tr_b16 a[118:119], v7 offset:34816
    v_mfma_f32_16x16x32_bf16 v[124:127], a[128:131], a[204:207], v[124:127]
    ds_read_b64_tr_b16 a[120:121], v10 offset:32768
    ds_read_b64_tr_b16 a[122:123], v10 offset:34816
    v_mfma_f32_16x16x32_bf16 v[104:107], a[128:131], a[192:195], v[104:107]
    s_waitcnt vmcnt(12) lgkmcnt(12)
    ds_read_b64_tr_b16 a[124:125], v13 offset:32768
    ds_read_b64_tr_b16 a[126:127], v13 offset:34816
    v_mfma_f32_16x16x32_bf16 v[108:111], a[132:135], a[212:215], v[108:111]
    buffer_load_dwordx4 a[180:183], v1, s[60:63], s70 offen offset:1024 sc1
    ds_read_b64_tr_b16 a[112:113], v4 offset:32768
    v_mfma_f32_16x16x32_bf16 v[120:123], a[132:135], a[216:219], v[120:123]
    s_add_u32 s70, s82, 229376
    ds_read_b64_tr_b16 a[114:115], v4 offset:34816
    ds_read_b64_tr_b16 a[228:229], v8 offset:32768
    v_mfma_f32_16x16x32_bf16 v[124:127], a[132:135], a[220:223], v[124:127]
    ds_read_b64_tr_b16 a[230:231], v8 offset:34816
    ds_read_b64_tr_b16 a[232:233], v11 offset:32768
    v_mfma_f32_16x16x32_bf16 v[104:107], a[132:135], a[208:211], v[104:107]
    s_waitcnt vmcnt(12) lgkmcnt(11)
    ds_read_b64_tr_b16 a[234:235], v11 offset:34816
    ds_read_b64_tr_b16 a[236:237], v14 offset:32768
    v_mfma_f32_16x16x32_bf16 v[108:111], a[136:139], a[100:103], v[108:111]
    buffer_load_dwordx4 a[0:3], v1, s[60:63], s70 offen offset:0 sc1
    ds_read_b64_tr_b16 a[238:239], v14 offset:34816
    v_mfma_f32_16x16x32_bf16 v[120:123], a[136:139], a[104:107], v[120:123]
    ds_read_b64_tr_b16 a[224:225], v5 offset:32768
    ds_read_b64_tr_b16 a[226:227], v5 offset:34816
    v_mfma_f32_16x16x32_bf16 v[124:127], a[136:139], a[108:111], v[124:127]
    ds_read_b64_tr_b16 a[244:245], v9 offset:0
    ds_read_b64_tr_b16 a[246:247], v9 offset:2048
    v_mfma_f32_16x16x32_bf16 v[104:107], a[136:139], a[96:99], v[104:107]
    s_waitcnt vmcnt(12) lgkmcnt(10)
    ds_read_b64_tr_b16 a[248:249], v12 offset:0
    ds_read_b64_tr_b16 a[250:251], v12 offset:2048
    v_mfma_f32_16x16x32_bf16 v[108:111], a[140:143], a[116:119], v[108:111]
    buffer_load_dwordx4 a[4:7], v1, s[60:63], s70 offen offset:1024 sc1
    ds_read_b64_tr_b16 a[252:253], v15 offset:0
    v_mfma_f32_16x16x32_bf16 v[120:123], a[140:143], a[120:123], v[120:123]
    ds_read_b64_tr_b16 a[254:255], v15 offset:2048
    ds_read_b64_tr_b16 a[240:241], v6 offset:0
    v_mfma_f32_16x16x32_bf16 v[124:127], a[140:143], a[124:127], v[124:127]
    ds_read_b64_tr_b16 a[242:243], v6 offset:2048
    v_lshrrev_b32 v36, 4, v0
    v_mfma_f32_16x16x32_bf16 v[104:107], a[140:143], a[112:115], v[104:107]
    s_waitcnt vmcnt(12) lgkmcnt(8)
    v_xor_b32 v30, s3, v36
    v_lshl_add_u32 v30, v36, 4, v30
    v_mfma_f32_16x16x32_bf16 v[108:111], a[144:147], a[228:231], v[108:111]
    buffer_load_dwordx4 a[8:11], v1, s[60:63], s70 offen offset:2048 sc1
    v_and_b32 v37, 15, v0
    v_mfma_f32_16x16x32_bf16 v[120:123], a[144:147], a[232:235], v[120:123]
    v_lshl_add_u32 v30, v30, 4, v37
    v_lshl_add_u32 v30, v30, 2, s85
    v_mfma_f32_16x16x32_bf16 v[124:127], a[144:147], a[236:239], v[124:127]
    v_xor_b32 v31, 64, v30
    v_xor_b32 v32, 128, v30
    v_mfma_f32_16x16x32_bf16 v[104:107], a[144:147], a[224:227], v[104:107]
    s_waitcnt vmcnt(12) lgkmcnt(0)
    v_xor_b32 v33, 192, v30
    v_mfma_f32_16x16x32_bf16 v[108:111], a[148:151], a[244:247], v[108:111]
    s_mul_i32 s46, s3, 1088
    buffer_load_dwordx4 a[12:15], v1, s[60:63], s70 offen offset:3072 sc1
    v_max3_u32 v34, v16, v18, v26
    v_mfma_f32_16x16x32_bf16 v[120:123], a[148:151], a[248:251], v[120:123]
    s_add_u32 s70, s82, 233472
    v_max_u32 v34, v34, v28
    v_xor_b32 v35, s46, v1
    v_mfma_f32_16x16x32_bf16 v[124:127], a[148:151], a[252:255], v[124:127]
    v_and_b32 v101, 15, v0
    v_lshrrev_b32 v102, 4, v0
    v_mfma_f32_16x16x32_bf16 v[104:107], a[148:151], a[240:243], v[104:107]
    s_waitcnt vmcnt(12)
    v_lshlrev_b32 v100, 3, v101
    v_lshl_add_u32 v100, v102, 10, v100
    v_mfma_f32_16x16x32_bf16 v[116:119], a[56:59], a[68:71], v[116:119]
    buffer_load_dwordx4 a[16:19], v1, s[60:63], s70 offen offset:0 sc1
    v_mfma_f32_16x16x32_bf16 v[128:131], a[56:59], a[72:75], v[128:131]
    ds_write_b32 v31, v108 offset:0
    v_mfma_f32_16x16x32_bf16 v[132:135], a[56:59], a[76:79], v[132:135]
    v_cmp_eq_u32 vcc, -1, v34
    v_mfma_f32_16x16x32_bf16 v[112:115], a[56:59], a[64:67], v[112:115]
    s_waitcnt vmcnt(12)
    ds_write_b32 v31, v109 offset:256
    v_mfma_f32_16x16x32_bf16 v[116:119], a[60:63], a[84:87], v[116:119]
    s_cbranch_vccnz LX_hr
LR_hr:
    v_mfma_f32_16x16x32_bf16 v[128:131], a[60:63], a[88:91], v[128:131]
    buffer_load_dwordx4 a[20:23], v1, s[60:63], s70 offen offset:1024 sc1
    v_mfma_f32_16x16x32_bf16 v[132:135], a[60:63], a[92:95], v[132:135]
    ds_write_b32 v31, v110 offset:512
    v_mfma_f32_16x16x32_bf16 v[112:115], a[60:63], a[80:83], v[112:115]
    s_waitcnt vmcnt(11)
    ds_write_b32 v31, v111 offset:768
    v_mfma_f32_16x16x32_bf16 v[116:119], a[160:163], a[196:199], v[116:119]
    buffer_load_dwordx4 a[24:27], v1, s[60:63], s70 offen offset:2048 sc1
    v_mfma_f32_16x16x32_bf16 v[128:131], a[160:163], a[200:203], v[128:131]
    ds_write_b32 v32, v120 offset:0
    v_mfma_f32_16x16x32_bf16 v[132:135], a[160:163], a[204:207], v[132:135]
    ds_write_b32 v32, v121 offset:256
    v_mfma_f32_16x16x32_bf16 v[112:115], a[160:163], a[192:195], v[112:115]
    s_waitcnt vmcnt(11)
    ds_write_b32 v32, v122 offset:512
    v_mfma_f32_16x16x32_bf16 v[116:119], a[164:167], a[212:215], v[116:119]
    buffer_load_dwordx4 a[28:31], v1, s[60:63], s70 offen offset:3072 sc1
    v_mfma_f32_16x16x32_bf16 v[128:131], a[164:167], a[216:219], v[128:131]
    s_add_u32 s70, s82, 237568
    ds_write_b32 v32, v123 offset:768
    v_mfma_f32_16x16x32_bf16 v[132:135], a[164:167], a[220:223], v[132:135]
    ds_write_b32 v33, v124 offset:0
    v_mfma_f32_16x16x32_bf16 v[112:115], a[164:167], a[208:211], v[112:115]
    s_waitcnt vmcnt(11)
    ds_write_b32 v33, v125 offset:256
    v_mfma_f32_16x16x32_bf16 v[116:119], a[168:171], a[100:103], v[116:119]
    buffer_load_dwordx4 a[128:131], v1, s[60:63], s70 offen offset:0 sc1
    v_mfma_f32_16x16x32_bf16 v[128:131], a[168:171], a[104:107], v[128:131]
    ds_write_b32 v33, v126 offset:512
    v_mfma_f32_16x16x32_bf16 v[132:135], a[168:171], a[108:111], v[132:135]
    ds_write_b32 v33, v127 offset:768
    v_mfma_f32_16x16x32_bf16 v[112:115], a[168:171], a[96:99], v[112:115]
    s_waitcnt vmcnt(11)
    ds_write_b32 v30, v104 offset:0
    v_mfma_f32_16x16x32_bf16 v[116:119], a[172:175], a[116:119], v[116:119]
    buffer_load_dwordx4 a[132:135], v1, s[60:63], s70 offen offset:1024 sc1
    v_mfma_f32_16x16x32_bf16 v[128:131], a[172:175], a[120:123], v[128:131]
    ds_write_b32 v30, v105 offset:256
    v_mfma_f32_16x16x32_bf16 v[132:135], a[172:175], a[124:127], v[132:135]
    ds_write_b32 v30, v106 offset:512
    v_mfma_f32_16x16x32_bf16 v[112:115], a[172:175], a[112:115], v[112:115]
    s_waitcnt vmcnt(11)
    ds_write_b32 v30, v107 offset:768
    v_mfma_f32_16x16x32_bf16 v[116:119], a[176:179], a[228:231], v[116:119]
    buffer_load_dwordx4 a[136:139], v1, s[60:63], s70 offen offset:2048 sc1
    v_mfma_f32_16x16x32_bf16 v[128:131], a[176:179], a[232:235], v[128:131]
    v_mfma_f32_16x16x32_bf16 v[132:135], a[176:179], a[236:239], v[132:135]
    s_waitcnt lgkmcnt(0)
    s_barrier
    v_mfma_f32_16x16x32_bf16 v[112:115], a[176:179], a[224:227], v[112:115]
    s_waitcnt vmcnt(11)
    ds_read_b128 v[144:147], v35 offset:0
    ds_read_b128 v[148:151], v35 offset:4096
    v_mfma_f32_16x16x32_bf16 v[116:119], a[180:183], a[244:247], v[116:119]
    buffer_load_dwordx4 a[140:143], v1, s[60:63], s70 offen offset:3072 sc1
    ds_read_b128 v[152:155], v35 offset:8192
    v_mfma_f32_16x16x32_bf16 v[128:131], a[180:183], a[248:251], v[128:131]
    s_add_u32 s70, s82, 241664
    ds_read_b128 v[156:159], v35 offset:12288
    v_mfma_f32_16x16x32_bf16 v[132:135], a[180:183], a[252:255], v[132:135]
    s_add_u32 s84, s78, 0
    v_lshlrev_b32 v136, 16, v16
    v_and_b32 v137, 0xffff0000, v16
    v_mfma_f32_16x16x32_bf16 v[112:115], a[180:183], a[240:243], v[112:115]
    s_waitcnt vmcnt(11)
    v_lshlrev_b32 v138, 16, v17
    v_and_b32 v139, 0xffff0000, v17
    v_mfma_f32_16x16x32_bf16 v[108:111], a[0:3], v[164:167], 0
    buffer_load_dwordx4 a[144:147], v1, s[60:63], s70 offen offset:0 sc1
    v_mfma_f32_16x16x32_bf16 v[120:123], a[0:3], v[168:171], 0
    s_waitcnt lgkmcnt(0)
    v_add_f32 v136, v136, v144
    v_add_f32 v137, v137, v145
    v_mfma_f32_16x16x32_bf16 v[124:127], a[0:3], v[172:175], 0
    v_add_f32 v138, v138, v146
    v_add_f32 v139, v139, v147
    v_mfma_f32_16x16x32_bf16 v[104:107], a[0:3], v[160:163], 0
    s_waitcnt vmcnt(11)
    v_add_f32 v136, v136, v148
    v_add_f32 v137, v137, v149
    v_mfma_f32_16x16x32_bf16 v[108:111], a[4:7], v[180:183], v[108:111]
    buffer_load_dwordx4 a[148:151], v1, s[60:63], s70 offen offset:1024 sc1
    v_add_f32 v138, v138, v150
    v_mfma_f32_16x16x32_bf16 v[120:123], a[4:7], v[184:187], v[120:123]
    s_add_u32 s70, s82, 344064
    v_add_f32 v139, v139, v151
    v_add_f32 v152, v152, v156
    v_mfma_f32_16x16x32_bf16 v[124:127], a[4:7], v[188:191], v[124:127]
    v_add_f32 v153, v153, v157
    v_add_f32 v154, v154, v158
    v_mfma_f32_16x16x32_bf16 v[104:107], a[4:7], v[176:179], v[104:107]
    s_waitcnt vmcnt(11)
    v_add_f32 v155, v155, v159
    v_add_f32 v136, v136, v152
    v_mfma_f32_16x16x32_bf16 v[108:111], a[8:11], v[196:199], v[108:111]
    buffer_load_dwordx4 v[40:43], v1, s[60:63], s70 offen offset:0 sc1
    v_add_f32 v137, v137, v153
    v_mfma_f32_16x16x32_bf16 v[120:123], a[8:11], v[200:203], v[120:123]
    v_add_f32 v138, v138, v154
    v_add_f32 v139, v139, v155
    v_mfma_f32_16x16x32_bf16 v[124:127], a[8:11], v[204:207], v[124:127]
    v_cvt_pk_bf16_f32 v16, v136, v137
    v_cvt_pk_bf16_f32 v17, v138, v139
    v_mfma_f32_16x16x32_bf16 v[104:107], a[8:11], v[192:195], v[104:107]
    s_waitcnt vmcnt(11)
    buffer_store_dwordx2 v[16:17], v100, s[56:59], s84 offen
    v_mfma_f32_16x16x32_bf16 v[108:111], a[12:15], v[212:215], v[108:111]
    buffer_load_dwordx4 v[44:47], v1, s[60:63], s70 offen offset:1024 sc1
    v_mfma_f32_16x16x32_bf16 v[120:123], a[12:15], v[216:219], v[120:123]
    ds_write_b32 v31, v116 offset:16384
    v_mfma_f32_16x16x32_bf16 v[124:127], a[12:15], v[220:223], v[124:127]
    ds_write_b32 v31, v117 offset:16640
    v_mfma_f32_16x16x32_bf16 v[104:107], a[12:15], v[208:211], v[104:107]
    s_waitcnt vmcnt(12)
    ds_write_b32 v31, v118 offset:16896
    v_mfma_f32_16x16x32_bf16 v[108:111], a[16:19], v[228:231], v[108:111]
    buffer_load_dwordx4 v[48:51], v1, s[60:63], s70 offen offset:2048 sc1
    v_add_u32 v99, s85, v1
    v_mfma_f32_16x16x32_bf16 v[120:123], a[16:19], v[232:235], v[120:123]
    ds_write_b32 v31, v119 offset:17152
    v_mfma_f32_16x16x32_bf16 v[124:127], a[16:19], v[236:239], v[124:127]
    ds_write_b32 v32, v128 offset:16384
    v_mfma_f32_16x16x32_bf16 v[104:107], a[16:19], v[224:227], v[104:107]
    s_waitcnt vmcnt(12)
    ds_write_b32 v32, v129 offset:16640
    v_mfma_f32_16x16x32_bf16 v[108:111], a[20:23], v[244:247], v[108:111]
    buffer_load_dwordx4 v[52:55], v1, s[60:63], s70 offen offset:3072 sc1
    v_xor_b32 v96, 4096, v99
    v_mfma_f32_16x16x32_bf16 v[120:123], a[20:23], v[248:251], v[120:123]
    s_add_u32 s70, s82, 348160
    ds_write_b32 v32, v130 offset:16896
    v_mfma_f32_16x16x32_bf16 v[124:127], a[20:23], v[252:255], v[124:127]
    ds_write_b32 v32, v131 offset:17152
    v_mfma_f32_16x16x32_bf16 v[104:107], a[20:23], v[240:243], v[104:107]
    s_waitcnt vmcnt(12)
    ds_write_b32 v33, v132 offset:16384
    v_mfma_f32_16x16x32_bf16 v[108:111], a[24:27], a[68:71], v[108:111]
    buffer_load_dwordx4 v[56:59], v1, s[60:63], s70 offen offset:0 sc1
    v_xor_b32 v97, 8192, v99
    v_mfma_f32_16x16x32_bf16 v[120:123], a[24:27], a[72:75], v[120:123]
    ds_write_b32 v33, v133 offset:16640
    v_mfma_f32_16x16x32_bf16 v[124:127], a[24:27], a[76:79], v[124:127]
    ds_write_b32 v33, v134 offset:16896
    v_mfma_f32_16x16x32_bf16 v[104:107], a[24:27], a[64:67], v[104:107]
    s_waitcnt vmcnt(12)
    ds_write_b32 v33, v135 offset:17152
    v_mfma_f32_16x16x32_bf16 v[108:111], a[28:31], a[84:87], v[108:111]
    buffer_load_dwordx4 v[60:63], v1, s[60:63], s70 offen offset:1024 sc1
    v_xor_b32 v98, 12288, v99
    v_mfma_f32_16x16x32_bf16 v[120:123], a[28:31], a[88:91], v[120:123]
    ds_write_b32 v30, v112 offset:16384
    v_mfma_f32_16x16x32_bf16 v[124:127], a[28:31], a[92:95], v[124:127]
    ds_write_b32 v30, v113 offset:16640
    v_mfma_f32_16x16x32_bf16 v[104:107], a[28:31], a[80:83], v[104:107]
    s_waitcnt vmcnt(12)
    ds_write_b32 v30, v114 offset:16896
    v_mfma_f32_16x16x32_bf16 v[108:111], a[128:131], a[196:199], v[108:111]
    buffer_load_dwordx4 v[64:67], v1, s[60:63], s70 offen offset:2048 sc1
    v_and_b32 v101, 15, v0
    v_mfma_f32_16x16x32_bf16 v[120:123], a[128:131], a[200:203], v[120:123]
    ds_write_b32 v30, v115 offset:17152
    v_mfma_f32_16x16x32_bf16 v[124:127], a[128:131], a[204:207], v[124:127]
    v_lshrrev_b32 v102, 4, v0
    v_lshlrev_b32 v2, 10, v101
    v_mfma_f32_16x16x32_bf16 v[104:107], a[128:131], a[192:195], v[104:107]
    s_waitcnt vmcnt(12)
    v_lshl_add_u32 v2, v102, 3, v2
    v_mfma_f32_16x16x32_bf16 v[108:111], a[132:135], a[212:215], v[108:111]
    buffer_load_dwordx4 v[68:71], v1, s[60:63], s70 offen offset:3072 sc1
    v_mfma_f32_16x16x32_bf16 v[120:123], a[132:135], a[216:219], v[120:123]
    s_add_u32 s70, s82, 352256
    v_mfma_f32_16x16x32_bf16 v[124:127], a[132:135], a[220:223], v[124:127]
    s_waitcnt lgkmcnt(0)
    s_barrier
    v_mfma_f32_16x16x32_bf16 v[104:107], a[132:135], a[208:211], v[104:107]
    s_waitcnt vmcnt(12)
    ds_read_b128 v[144:147], v35 offset:16384
    ds_read_b128 v[148:151], v35 offset:20480
    v_mfma_f32_16x16x32_bf16 v[108:111], a[136:139], a[100:103], v[108:111]
    buffer_load_dwordx4 v[72:75], v1, s[60:63], s70 offen offset:0 sc1
    ds_read_b128 v[152:155], v35 offset:24576
    v_mfma_f32_16x16x32_bf16 v[120:123], a[136:139], a[104:107], v[120:123]
    ds_read_b128 v[156:159], v35 offset:28672
    v_mfma_f32_16x16x32_bf16 v[124:127], a[136:139], a[108:111], v[124:127]
    s_add_u32 s84, s78, 32768
    v_lshlrev_b32 v136, 16, v18
    v_and_b32 v137, 0xffff0000, v18
    v_mfma_f32_16x16x32_bf16 v[104:107], a[136:139], a[96:99], v[104:107]
    s_waitcnt vmcnt(12)
    v_lshlrev_b32 v138, 16, v19
    v_and_b32 v139, 0xffff0000, v19
    v_mfma_f32_16x16x32_bf16 v[108:111], a[140:143], a[116:119], v[108:111]
    buffer_load_dwordx4 v[76:79], v1, s[60:63], s70 offen offset:1024 sc1
    v_mfma_f32_16x16x32_bf16 v[120:123], a[140:143], a[120:123], v[120:123]
    s_waitcnt lgkmcnt(0)
    v_add_f32 v136, v136, v144
    v_add_f32 v137, v137, v145
    v_mfma_f32_16x16x32_bf16 v[124:127], a[140:143], a[124:127], v[124:127]
    v_add_f32 v138, v138, v146
    v_add_f32 v139, v139, v147
    v_mfma_f32_16x16x32_bf16 v[104:107], a[140:143], a[112:115], v[104:107]
    s_waitcnt vmcnt(12)
    v_add_f32 v136, v136, v148
    v_add_f32 v137, v137, v149
    v_mfma_f32_16x16x32_bf16 v[108:111], a[144:147], a[228:231], v[108:111]
    buffer_load_dwordx4 v[80:83], v1, s[60:63], s70 offen offset:2048 sc1
    v_add_f32 v138, v138, v150
    v_mfma_f32_16x16x32_bf16 v[120:123], a[144:147], a[232:235], v[120:123]
    v_add_f32 v139, v139, v151
    v_add_f32 v152, v152, v156
    v_mfma_f32_16x16x32_bf16 v[124:127], a[144:147], a[236:239], v[124:127]
    v_add_f32 v153, v153, v157
    v_add_f32 v154, v154, v158
    v_mfma_f32_16x16x32_bf16 v[104:107], a[144:147], a[224:227], v[104:107]
    s_waitcnt vmcnt(12)
    v_add_f32 v155, v155, v159
    v_add_f32 v136, v136, v152
    v_mfma_f32_16x16x32_bf16 v[108:111], a[148:151], a[244:247], v[108:111]
    buffer_load_dwordx4 v[84:87], v1, s[60:63], s70 offen offset:3072 sc1
    v_add_f32 v137, v137, v153
    v_mfma_f32_16x16x32_bf16 v[120:123], a[148:151], a[248:251], v[120:123]
    s_waitcnt vmcnt(9)
    v_max3_u32 v24, v40, v44, v48
    v_cmp_eq_u32 vcc, -1, v24
    v_mfma_f32_16x16x32_bf16 v[124:127], a[148:151], a[252:255], v[124:127]
    s_add_u32 s70, s82, 356352
    v_add_f32 v138, v138, v154
    v_add_f32 v139, v139, v155
    v_mfma_f32_16x16x32_bf16 v[104:107], a[148:151], a[240:243], v[104:107]
    s_cbranch_vccnz LX_a0
LR_a0:
    v_mfma_f32_16x16x32_bf16 v[116:119], v[164:167], v[40:43], 0
    v_add_f32 v36, v108, v109
    v_add_f32 v37, v110, v111
    v_mfma_f32_16x16x32_bf16 v[128:131], v[168:171], v[40:43], 0
    buffer_load_dwordx4 v[88:91], v1, s[60:63], s70 offen offset:0 sc1
    v_cmp_u_f32 vcc, v36, v37
    v_mfma_f32_16x16x32_bf16 v[132:135], v[172:175], v[40:43], 0
    v_cvt_pk_bf16_f32 v18, v136, v137
    v_cvt_pk_bf16_f32 v19, v138, v139
    buffer_store_dwordx2 v[18:19], v100, s[56:59], s84 offen
    v_mfma_f32_16x16x32_bf16 v[112:115], v[160:163], v[40:43], 0
    s_cbranch_vccnz LX_m2
LR_m2:
    v_mfma_f32_16x16x32_bf16 v[116:119], v[180:183], v[44:47], v[116:119]
    buffer_load_dwordx4 v[92:95], v1, s[60:63], s70 offen offset:1024 sc1
    v_mfma_f32_16x16x32_bf16 v[128:131], v[184:187], v[44:47], v[128:131]
    ds_write_b32 v31, v108 offset:32768
    v_mfma_f32_16x16x32_bf16 v[132:135], v[188:191], v[44:47], v[132:135]
    ds_write_b32 v31, v109 offset:33024
    v_mfma_f32_16x16x32_bf16 v[112:115], v[176:179], v[44:47], v[112:115]
    ds_write_b32 v31, v110 offset:33280
    v_mfma_f32_16x16x32_bf16 v[116:119], v[196:199], v[48:51], v[116:119]
    ds_write_b32 v31, v111 offset:33536
    v_mfma_f32_16x16x32_bf16 v[128:131], v[200:203], v[48:51], v[128:131]
    s_waitcnt vmcnt(9)
    v_max3_u32 v24, v52, v56, v60
    v_cmp_eq_u32 vcc, -1, v24
    v_mfma_f32_16x16x32_bf16 v[132:135], v[204:207], v[48:51], v[132:135]
    ds_write_b32 v32, v120 offset:32768
    v_mfma_f32_16x16x32_bf16 v[112:115], v[192:195], v[48:51], v[112:115]
    s_cbranch_vccnz LX_a3
LR_a3:
    v_mfma_f32_16x16x32_bf16 v[116:119], v[212:215], v[52:55], v[116:119]
    ds_write_b32 v32, v121 offset:33024
    v_mfma_f32_16x16x32_bf16 v[128:131], v[216:219], v[52:55], v[128:131]
Lpad_est3:
Lpad_8:
    s_cbranch_execz Lpad_retst
    ds_write_b32 v32, v122 offset:33280
    v_mfma_f32_16x16x32_bf16 v[132:135], v[220:223], v[52:55], v[132:135]
    ds_write_b32 v32, v123 offset:33536
    v_mfma_f32_16x16x32_bf16 v[112:115], v[208:211], v[52:55], v[112:115]
    ds_write_b32 v33, v124 offset:32768
    v_mfma_f32_16x16x32_bf16 v[116:119], v[228:231], v[56:59], v[116:119]
    ds_write_b32 v33, v125 offset:33024
    v_mfma_f32_16x16x32_bf16 v[128:131], v[232:235], v[56:59], v[128:131]
    ds_write_b32 v33, v126 offset:33280
    v_mfma_f32_16x16x32_bf16 v[132:135], v[236:239], v[56:59], v[132:135]
    ds_write_b32 v33, v127 offset:33536
    v_mfma_f32_16x16x32_bf16 v[112:115], v[224:227], v[56:59], v[112:115]
    ds_write_b32 v30, v104 offset:32768
    v_mfma_f32_16x16x32_bf16 v[116:119], v[244:247], v[60:63], v[116:119]
    ds_write_b32 v30, v105 offset:33024
    v_mfma_f32_16x16x32_bf16 v[128:131], v[248:251], v[60:63], v[128:131]
    s_waitcnt vmcnt(6)
    v_max3_u32 v24, v64, v68, v72
    v_cmp_eq_u32 vcc, -1, v24
    v_mfma_f32_16x16x32_bf16 v[132:135], v[252:255], v[60:63], v[132:135]
    ds_write_b32 v30, v106 offset:33280
    v_mfma_f32_16x16x32_bf16 v[112:115], v[240:243], v[60:63], v[112:115]
    s_cbranch_vccnz LX_a6
LR_a6:
    v_mfma_f32_16x16x32_bf16 v[116:119], a[68:71], v[64:67], v[116:119]
    ds_write_b32 v30, v107 offset:33536
    v_mfma_f32_16x16x32_bf16 v[128:131], a[72:75], v[64:67], v[128:131]
    v_mfma_f32_16x16x32_bf16 v[132:135], a[76:79], v[64:67], v[132:135]
    v_mfma_f32_16x16x32_bf16 v[116:119], a[84:87], v[68:71], v[116:119]
    v_mfma_f32_16x16x32_bf16 v[128:131], a[88:91], v[68:71], v[128:131]
    s_waitcnt lgkmcnt(0)
    s_barrier
    v_mfma_f32_16x16x32_bf16 v[132:135], a[92:95], v[68:71], v[132:135]
    ds_read_b128 v[144:147], v35 offset:32768
    ds_read_b128 v[148:151], v35 offset:36864
    v_mfma_f32_16x16x32_bf16 v[116:119], a[196:199], v[72:75], v[116:119]
    s_waitcnt vmcnt(3)
    v_max3_u32 v24, v76, v80, v84
    v_cmp_eq_u32 vcc, -1, v24
    v_mfma_f32_16x16x32_bf16 v[128:131], a[200:203], v[72:75], v[128:131]
    ds_read_b128 v[152:155], v35 offset:40960
    ds_read_b128 v[156:159], v35 offset:45056
    v_mfma_f32_16x16x32_bf16 v[132:135], a[204:207], v[72:75], v[132:135]
    s_cbranch_vccnz LX_a9
LR_a9:
    v_mfma_f32_16x16x32_bf16 v[116:119], a[212:215], v[76:79], v[116:119]
    s_add_u32 s84, s78, 65536
    v_lshlrev_b32 v136, 16, v26
    v_and_b32 v137, 0xffff0000, v26
    v_lshlrev_b32 v138, 16, v27
    v_and_b32 v139, 0xffff0000, v27
    v_mfma_f32_16x16x32_bf16 v[128:131], a[216:219], v[76:79], v[128:131]
    s_waitcnt lgkmcnt(0)
    v_add_f32 v136, v136, v144
    v_add_f32 v137, v137, v145
    v_mfma_f32_16x16x32_bf16 v[132:135], a[220:223], v[76:79], v[132:135]
    v_add_f32 v138, v138, v146
    v_add_f32 v139, v139, v147
    v_mfma_f32_16x16x32_bf16 v[116:119], a[100:103], v[80:83], v[116:119]
    v_add_f32 v136, v136, v148
    v_add_f32 v137, v137, v149
    v_mfma_f32_16x16x32_bf16 v[128:131], a[104:107], v[80:83], v[128:131]
    v_add_f32 v138, v138, v150
    v_add_f32 v139, v139, v151
    v_mfma_f32_16x16x32_bf16 v[132:135], a[108:111], v[80:83], v[132:135]
    v_add_f32 v152, v152, v156
    v_add_f32 v153, v153, v157
    v_mfma_f32_16x16x32_bf16 v[116:119], a[116:119], v[84:87], v[116:119]
    s_waitcnt vmcnt(0)
    v_max_u32 v24, v88, v92
    v_cmp_eq_u32 vcc, -1, v24
    v_mfma_f32_16x16x32_bf16 v[128:131], a[120:123], v[84:87], v[128:131]
    v_add_f32 v154, v154, v158
    v_add_f32 v155, v155, v159
    v_mfma_f32_16x16x32_bf16 v[132:135], a[124:127], v[84:87], v[132:135]
    s_cbranch_vccnz LX_a12
LR_a12:
    v_mfma_f32_16x16x32_bf16 v[116:119], a[228:231], v[88:91], v[116:119]
    v_add_f32 v136, v136, v152
    v_add_f32 v137, v137, v153
    v_mfma_f32_16x16x32_bf16 v[116:119], a[244:247], v[92:95], v[116:119]
    v_add_f32 v138, v138, v154
    v_add_f32 v139, v139, v155
    v_mfma_f32_16x16x32_bf16 v[128:131], a[232:235], v[88:91], v[128:131]
    v_cvt_pk_bf16_f32 v26, v136, v137
    v_cvt_pk_bf16_f32 v27, v138, v139
    v_mfma_f32_16x16x32_bf16 v[128:131], a[248:251], v[92:95], v[128:131]
    s_nop 1
    ds_write_b128 v99, v[116:119] offset:50176
    v_mfma_f32_16x16x32_bf16 v[132:135], a[236:239], v[88:91], v[132:135]
    buffer_store_dwordx2 v[26:27], v100, s[56:59], s84 offen
    v_mfma_f32_16x16x32_bf16 v[132:135], a[252:255], v[92:95], v[132:135]
    s_nop 1
    ds_write_b128 v99, v[128:131] offset:51200
    v_mfma_f32_16x16x32_bf16 v[112:115], a[64:67], v[64:67], v[112:115]
    v_lshlrev_b32 v136, 16, v28
    v_and_b32 v137, 0xffff0000, v28
    v_mfma_f32_16x16x32_bf16 v[112:115], a[80:83], v[68:71], v[112:115]
    s_nop 0
    ds_write_b128 v99, v[132:135] offset:52224
    v_mfma_f32_16x16x32_bf16 v[112:115], a[192:195], v[72:75], v[112:115]
    v_lshlrev_b32 v138, 16, v29
    v_and_b32 v139, 0xffff0000, v29
    v_mfma_f32_16x16x32_bf16 v[112:115], a[208:211], v[76:79], v[112:115]
    v_mfma_f32_16x16x32_bf16 v[112:115], a[96:99], v[80:83], v[112:115]
    s_waitcnt lgkmcnt(0)
    s_barrier
    v_mfma_f32_16x16x32_bf16 v[112:115], a[112:115], v[84:87], v[112:115]
    ds_read_b128 v[144:147], v96 offset:50176
    ds_read_b128 v[148:151], v97 offset:51200
    ds_read_b128 v[152:155], v98 offset:52224
    v_mfma_f32_16x16x32_bf16 v[112:115], a[224:227], v[88:91], v[112:115]
    v_mfma_f32_16x16x32_bf16 v[112:115], a[240:243], v[92:95], v[112:115]
    s_waitcnt lgkmcnt(1)
    v_pk_add_f32 v[144:145], v[144:145], v[148:149]
    v_pk_add_f32 v[146:147], v[146:147], v[150:151]
    s_waitcnt lgkmcnt(0)
    v_pk_add_f32 v[136:137], v[136:137], v[152:153]
    v_pk_add_f32 v[138:139], v[138:139], v[154:155]
    v_pk_add_f32 v[136:137], v[136:137], v[144:145]
    v_pk_add_f32 v[138:139], v[138:139], v[146:147]
    v_pk_add_f32 v[136:137], v[136:137], v[112:113]
    v_pk_add_f32 v[138:139], v[138:139], v[114:115]
    v_cvt_pk_bf16_f32 v28, v136, v137
    v_cvt_pk_bf16_f32 v29, v138, v139
    buffer_store_dwordx2 v[28:29], v2, s[56:59], s65 offen
Lend:
    s_endpgm
LX_m2:
    s_add_u32 s45, s82, 229376
    buffer_load_dwordx4 a[0:3], v1, s[60:63], s45 offen offset:0 sc1
    buffer_load_dwordx4 a[4:7], v1, s[60:63], s45 offen offset:1024 sc1
    buffer_load_dwordx4 a[8:11], v1, s[60:63], s45 offen offset:2048 sc1
    buffer_load_dwordx4 a[12:15], v1, s[60:63], s45 offen offset:3072 sc1
    s_add_u32 s45, s82, 233472
    buffer_load_dwordx4 a[16:19], v1, s[60:63], s45 offen offset:0 sc1
    buffer_load_dwordx4 a[20:23], v1, s[60:63], s45 offen offset:1024 sc1
    buffer_load_dwordx4 a[24:27], v1, s[60:63], s45 offen offset:2048 sc1
    buffer_load_dwordx4 a[28:31], v1, s[60:63], s45 offen offset:3072 sc1
    s_add_u32 s45, s82, 237568
    buffer_load_dwordx4 a[128:131], v1, s[60:63], s45 offen offset:0 sc1
    buffer_load_dwordx4 a[132:135], v1, s[60:63], s45 offen offset:1024 sc1
    buffer_load_dwordx4 a[136:139], v1, s[60:63], s45 offen offset:2048 sc1
    buffer_load_dwordx4 a[140:143], v1, s[60:63], s45 offen offset:3072 sc1
    s_add_u32 s45, s82, 241664
    buffer_load_dwordx4 a[144:147], v1, s[60:63], s45 offen offset:0 sc1
    buffer_load_dwordx4 a[148:151], v1, s[60:63], s45 offen offset:1024 sc1
    s_waitcnt vmcnt(0)
    v_mov_b32 v24, 0
    v_accvgpr_read_b32 v101, a0
    v_accvgpr_read_b32 v102, a4
    v_max3_u32 v24, v24, v101, v102
    v_accvgpr_read_b32 v101, a8
    v_accvgpr_read_b32 v102, a12
    v_max3_u32 v24, v24, v101, v102
    v_accvgpr_read_b32 v101, a16
    v_accvgpr_read_b32 v102, a20
    v_max3_u32 v24, v24, v101, v102
    v_accvgpr_read_b32 v101, a24
    v_accvgpr_read_b32 v102, a28
    v_max3_u32 v24, v24, v101, v102
    v_accvgpr_read_b32 v101, a128
    v_accvgpr_read_b32 v102, a132
    v_max3_u32 v24, v24, v101, v102
    v_accvgpr_read_b32 v101, a136
    v_accvgpr_read_b32 v102, a140
    v_max3_u32 v24, v24, v101, v102
    v_accvgpr_read_b32 v101, a144
    v_accvgpr_read_b32 v102, a148
    v_max3_u32 v24, v24, v101, v102
    v_cmp_eq_u32 vcc, -1, v24
    s_cbranch_vccnz LX_m2
    v_mfma_f32_16x16x32_bf16 v[108:111], a[0:3], v[164:167], 0
    v_mfma_f32_16x16x32_bf16 v[120:123], a[0:3], v[168:171], 0
    v_mfma_f32_16x16x32_bf16 v[124:127], a[0:3], v[172:175], 0
    v_mfma_f32_16x16x32_bf16 v[104:107], a[0:3], v[160:163], 0
    v_mfma_f32_16x16x32_bf16 v[108:111], a[4:7], v[180:183], v[108:111]
    v_mfma_f32_16x16x32_bf16 v[120:123], a[4:7], v[184:187], v[120:123]
    v_mfma_f32_16x16x32_bf16 v[124:127], a[4:7], v[188:191], v[124:127]
    v_mfma_f32_16x16x32_bf16 v[104:107], a[4:7], v[176:179], v[104:107]
    v_mfma_f32_16x16x32_bf16 v[108:111], a[8:11], v[196:199], v[108:111]
    v_mfma_f32_16x16x32_bf16 v[120:123], a[8:11], v[200:203], v[120:123]
    v_mfma_f32_16x16x32_bf16 v[124:127], a[8:11], v[204:207], v[124:127]
    v_mfma_f32_16x16x32_bf16 v[104:107], a[8:11], v[192:195], v[104:107]
    v_mfma_f32_16x16x32_bf16 v[108:111], a[12:15], v[212:215], v[108:111]
    v_mfma_f32_16x16x32_bf16 v[120:123], a[12:15], v[216:219], v[120:123]
    v_mfma_f32_16x16x32_bf16 v[124:127], a[12:15], v[220:223], v[124:127]
    v_mfma_f32_16x16x32_bf16 v[104:107], a[12:15], v[208:211], v[104:107]
    v_mfma_f32_16x16x32_bf16 v[108:111], a[16:19], v[228:231], v[108:111]
    v_mfma_f32_16x16x32_bf16 v[120:123], a[16:19], v[232:235], v[120:123]
    v_mfma_f32_16x16x32_bf16 v[124:127], a[16:19], v[236:239], v[124:127]
    v_mfma_f32_16x16x32_bf16 v[104:107], a[16:19], v[224:227], v[104:107]
    v_mfma_f32_16x16x32_bf16 v[108:111], a[20:23], v[244:247], v[108:111]
    v_mfma_f32_16x16x32_bf16 v[120:123], a[20:23], v[248:251], v[120:123]
    v_mfma_f32_16x16x32_bf16 v[124:127], a[20:23], v[252:255], v[124:127]
    v_mfma_f32_16x16x32_bf16 v[104:107], a[20:23], v[240:243], v[104:107]
    v_mfma_f32_16x16x32_bf16 v[108:111], a[24:27], a[68:71], v[108:111]
    v_mfma_f32_16x16x32_bf16 v[120:123], a[24:27], a[72:75], v[120:123]
    v_mfma_f32_16x16x32_bf16 v[124:127], a[24:27], a[76:79], v[124:127]
    v_mfma_f32_16x16x32_bf16 v[104:107], a[24:27], a[64:67], v[104:107]
    v_mfma_f32_16x16x32_bf16 v[108:111], a[28:31], a[84:87], v[108:111]
    v_mfma_f32_16x16x32_bf16 v[120:123], a[28:31], a[88:91], v[120:123]
    v_mfma_f32_16x16x32_bf16 v[124:127], a[28:31], a[92:95], v[124:127]
    v_mfma_f32_16x16x32_bf16 v[104:107], a[28:31], a[80:83], v[104:107]
    v_mfma_f32_16x16x32_bf16 v[108:111], a[128:131], a[196:199], v[108:111]
    v_mfma_f32_16x16x32_bf16 v[120:123], a[128:131], a[200:203], v[120:123]
    v_mfma_f32_16x16x32_bf16 v[124:127], a[128:131], a[204:207], v[124:127]
    v_mfma_f32_16x16x32_bf16 v[104:107], a[128:131], a[192:195], v[104:107]
    v_mfma_f32_16x16x32_bf16 v[108:111], a[132:135], a[212:215], v[108:111]
    v_mfma_f32_16x16x32_bf16 v[120:123], a[132:135], a[216:219], v[120:123]
    v_mfma_f32_16x16x32_bf16 v[124:127], a[132:135], a[220:223], v[124:127]
    v_mfma_f32_16x16x32_bf16 v[104:107], a[132:135], a[208:211], v[104:107]
    v_mfma_f32_16x16x32_bf16 v[108:111], a[136:139], a[100:103], v[108:111]
    v_mfma_f32_16x16x32_bf16 v[120:123], a[136:139], a[104:107], v[120:123]
    v_mfma_f32_16x16x32_bf16 v[124:127], a[136:139], a[108:111], v[124:127]
    v_mfma_f32_16x16x32_bf16 v[104:107], a[136:139], a[96:99], v[104:107]
    v_mfma_f32_16x16x32_bf16 v[108:111], a[140:143], a[116:119], v[108:111]
    v_mfma_f32_16x16x32_bf16 v[120:123], a[140:143], a[120:123], v[120:123]
    v_mfma_f32_16x16x32_bf16 v[124:127], a[140:143], a[124:127], v[124:127]
    v_mfma_f32_16x16x32_bf16 v[104:107], a[140:143], a[112:115], v[104:107]
    v_mfma_f32_16x16x32_bf16 v[108:111], a[144:147], a[228:231], v[108:111]
    v_mfma_f32_16x16x32_bf16 v[120:123], a[144:147], a[232:235], v[120:123]
    v_mfma_f32_16x16x32_bf16 v[124:127], a[144:147], a[236:239], v[124:127]
    v_mfma_f32_16x16x32_bf16 v[104:107], a[144:147], a[224:227], v[104:107]
    v_mfma_f32_16x16x32_bf16 v[108:111], a[148:151], a[244:247], v[108:111]
    v_mfma_f32_16x16x32_bf16 v[120:123], a[148:151], a[248:251], v[120:123]
    v_mfma_f32_16x16x32_bf16 v[124:127], a[148:151], a[252:255], v[124:127]
    v_mfma_f32_16x16x32_bf16 v[104:107], a[148:151], a[240:243], v[104:107]
    s_nop 7
    s_branch LR_m2
LX_a12:
    s_add_u32 s45, s82, 356352
    buffer_load_dwordx4 v[88:91], v1, s[60:63], s45 offen offset:0 sc1
    buffer_load_dwordx4 v[92:95], v1, s[60:63], s45 offen offset:1024 sc1
    s_waitcnt vmcnt(0)
    v_max_u32 v24, v88, v92
    v_cmp_eq_u32 vcc, -1, v24
    s_cbranch_vccnz LX_a12
    s_branch LR_a12
LX_a9:
    s_add_u32 s45, s82, 352256
    buffer_load_dwordx4 v[76:79], v1, s[60:63], s45 offen offset:1024 sc1
    buffer_load_dwordx4 v[80:83], v1, s[60:63], s45 offen offset:2048 sc1
    buffer_load_dwordx4 v[84:87], v1, s[60:63], s45 offen offset:3072 sc1
    s_add_u32 s45, s82, 356352
    buffer_load_dwordx4 v[88:91], v1, s[60:63], s45 offen offset:0 sc1
    buffer_load_dwordx4 v[92:95], v1, s[60:63], s45 offen offset:1024 sc1
    s_waitcnt vmcnt(0)
    v_max3_u32 v24, v76, v80, v84
    v_cmp_eq_u32 vcc, -1, v24
    s_cbranch_vccnz LX_a9
    s_branch LR_a9
LX_a6:
    s_add_u32 s45, s82, 348160
    buffer_load_dwordx4 v[64:67], v1, s[60:63], s45 offen offset:2048 sc1
    buffer_load_dwordx4 v[68:71], v1, s[60:63], s45 offen offset:3072 sc1
    s_add_u32 s45, s82, 352256
    buffer_load_dwordx4 v[72:75], v1, s[60:63], s45 offen offset:0 sc1
    buffer_load_dwordx4 v[76:79], v1, s[60:63], s45 offen offset:1024 sc1
    buffer_load_dwordx4 v[80:83], v1, s[60:63], s45 offen offset:2048 sc1
    buffer_load_dwordx4 v[84:87], v1, s[60:63], s45 offen offset:3072 sc1
    s_add_u32 s45, s82, 356352
    buffer_load_dwordx4 v[88:91], v1, s[60:63], s45 offen offset:0 sc1
    buffer_load_dwordx4 v[92:95], v1, s[60:63], s45 offen offset:1024 sc1
    s_waitcnt vmcnt(0)
    v_max3_u32 v24, v64, v68, v72
    v_cmp_eq_u32 vcc, -1, v24
    s_cbranch_vccnz LX_a6
    s_branch LR_a6
LX_a3:
    s_add_u32 s45, s82, 344064
    buffer_load_dwordx4 v[52:55], v1, s[60:63], s45 offen offset:3072 sc1
    s_add_u32 s45, s82, 348160
    buffer_load_dwordx4 v[56:59], v1, s[60:63], s45 offen offset:0 sc1
    buffer_load_dwordx4 v[60:63], v1, s[60:63], s45 offen offset:1024 sc1
    buffer_load_dwordx4 v[64:67], v1, s[60:63], s45 offen offset:2048 sc1
    buffer_load_dwordx4 v[68:71], v1, s[60:63], s45 offen offset:3072 sc1
    s_add_u32 s45, s82, 352256
    buffer_load_dwordx4 v[72:75], v1, s[60:63], s45 offen offset:0 sc1
    buffer_load_dwordx4 v[76:79], v1, s[60:63], s45 offen offset:1024 sc1
    buffer_load_dwordx4 v[80:83], v1, s[60:63], s45 offen offset:2048 sc1
    buffer_load_dwordx4 v[84:87], v1, s[60:63], s45 offen offset:3072 sc1
    s_add_u32 s45, s82, 356352
    buffer_load_dwordx4 v[88:91], v1, s[60:63], s45 offen offset:0 sc1
    buffer_load_dwordx4 v[92:95], v1, s[60:63], s45 offen offset:1024 sc1
    s_waitcnt vmcnt(0)
    v_max3_u32 v24, v52, v56, v60
    v_cmp_eq_u32 vcc, -1, v24
    s_cbranch_vccnz LX_a3
    s_branch LR_a3
LX_a0:
    s_add_u32 s45, s82, 344064
    buffer_load_dwordx4 v[40:43], v1, s[60:63], s45 offen offset:0 sc1
    buffer_load_dwordx4 v[44:47], v1, s[60:63], s45 offen offset:1024 sc1
    buffer_load_dwordx4 v[48:51], v1, s[60:63], s45 offen offset:2048 sc1
    buffer_load_dwordx4 v[52:55], v1, s[60:63], s45 offen offset:3072 sc1
    s_add_u32 s45, s82, 348160
    buffer_load_dwordx4 v[56:59], v1, s[60:63], s45 offen offset:0 sc1
    buffer_load_dwordx4 v[60:63], v1, s[60:63], s45 offen offset:1024 sc1
    buffer_load_dwordx4 v[64:67], v1, s[60:63], s45 offen offset:2048 sc1
    buffer_load_dwordx4 v[68:71], v1, s[60:63], s45 offen offset:3072 sc1
    s_add_u32 s45, s82, 352256
    buffer_load_dwordx4 v[72:75], v1, s[60:63], s45 offen offset:0 sc1
    buffer_load_dwordx4 v[76:79], v1, s[60:63], s45 offen offset:1024 sc1
    buffer_load_dwordx4 v[80:83], v1, s[60:63], s45 offen offset:2048 sc1
    buffer_load_dwordx4 v[84:87], v1, s[60:63], s45 offen offset:3072 sc1
    s_add_u32 s45, s82, 356352
    buffer_load_dwordx4 v[88:91], v1, s[60:63], s45 offen offset:0 sc1
    buffer_load_dwordx4 v[92:95], v1, s[60:63], s45 offen offset:1024 sc1
    s_waitcnt vmcnt(0)
    v_max3_u32 v24, v40, v44, v48
    v_cmp_eq_u32 vcc, -1, v24
    s_cbranch_vccnz LX_a0
    s_branch LR_a0
LX_p2:
    buffer_load_dword v34, v23, s[60:63], s79 offen offset:256 sc1
    s_waitcnt vmcnt(0)
    v_cmp_gt_u32 vcc, 1, v34
    s_cbranch_vccnz LX_p2
    s_branch LR_p2
LX_p1:
    buffer_load_dword v24, v23, s[60:63], s79 offen offset:0 sc1
    s_waitcnt vmcnt(0)
    v_cmp_gt_u32 vcc, 1, v24
    s_cbranch_vccnz LX_p1
    s_branch LR_p1
LX_hr:
    s_add_u32 s45, s86, 0
    buffer_load_dwordx2 v[16:17], v25, s[60:63], s45 offen sc1
    s_add_u32 s45, s86, 32768
    buffer_load_dwordx2 v[18:19], v25, s[60:63], s45 offen sc1
    s_add_u32 s45, s86, 65536
    buffer_load_dwordx2 v[26:27], v25, s[60:63], s45 offen sc1
    buffer_load_dwordx2 v[28:29], v1, s[60:63], s66 offen sc1
    s_waitcnt vmcnt(0)
    v_max3_u32 v34, v16, v18, v26
    v_max_u32 v34, v34, v28
    v_cmp_eq_u32 vcc, -1, v34
    s_cbranch_vccnz LX_hr
    s_branch LR_hr
LX_h7:
    s_mov_b32 s44, m0
    s_add_u32 m0, s85, 114688
    s_add_u32 s45, s73, 114688
    buffer_load_dwordx4 v1, s[60:63], s45 offen offset:0 sc1 lds
    buffer_load_dwordx4 v1, s[60:63], s45 offen offset:1024 sc1 lds
    buffer_load_dwordx4 v1, s[60:63], s45 offen offset:2048 sc1 lds
    buffer_load_dwordx4 v1, s[60:63], s45 offen offset:3072 sc1 lds
    s_mov_b32 m0, s44
    s_waitcnt vmcnt(0)
    ds_read2st64_b32 v[30:31], v3 offset0:192 offset1:196
    ds_read2st64_b32 v[32:33], v3 offset0:200 offset1:204
    s_waitcnt lgkmcnt(0)
    v_max3_u32 v30, v30, v31, v32
    v_max_u32 v30, v30, v33
    v_cmp_eq_u32 vcc, -1, v30
    s_cbranch_vccnz LX_h7
    s_branch LR_h7
LX_h6:
    s_mov_b32 s44, m0
    s_add_u32 m0, s85, 98304
    s_add_u32 s45, s73, 98304
    buffer_load_dwordx4 v1, s[60:63], s45 offen offset:0 sc1 lds
    buffer_load_dwordx4 v1, s[60:63], s45 offen offset:1024 sc1 lds
    buffer_load_dwordx4 v1, s[60:63], s45 offen offset:2048 sc1 lds
    buffer_load_dwordx4 v1, s[60:63], s45 offen offset:3072 sc1 lds
    s_mov_b32 m0, s44
    s_waitcnt vmcnt(0)
    ds_read2st64_b32 v[30:31], v3 offset0:128 offset1:132
    ds_read2st64_b32 v[32:33], v3 offset0:136 offset1:140
    s_waitcnt lgkmcnt(0)
    v_max3_u32 v30, v30, v31, v32
    v_max_u32 v30, v30, v33
    v_cmp_eq_u32 vcc, -1, v30
    s_cbranch_vccnz LX_h6
    s_branch LR_h6
LX_h5:
    s_mov_b32 s44, m0
    s_add_u32 m0, s85, 81920
    s_add_u32 s45, s73, 81920
    buffer_load_dwordx4 v1, s[60:63], s45 offen offset:0 sc1 lds
    buffer_load_dwordx4 v1, s[60:63], s45 offen offset:1024 sc1 lds
    buffer_load_dwordx4 v1, s[60:63], s45 offen offset:2048 sc1 lds
    buffer_load_dwordx4 v1, s[60:63], s45 offen offset:3072 sc1 lds
    s_mov_b32 m0, s44
    s_waitcnt vmcnt(0)
    ds_read2st64_b32 v[30:31], v3 offset0:64 offset1:68
    ds_read2st64_b32 v[32:33], v3 offset0:72 offset1:76
    s_waitcnt lgkmcnt(0)
    v_max3_u32 v30, v30, v31, v32
    v_max_u32 v30, v30, v33
    v_cmp_eq_u32 vcc, -1, v30
    s_cbranch_vccnz LX_h5
    s_branch LR_h5
LX_h4:
    s_mov_b32 s44, m0
    s_add_u32 m0, s85, 65536
    s_add_u32 s45, s73, 65536
    buffer_load_dwordx4 v1, s[60:63], s45 offen offset:0 sc1 lds
    buffer_load_dwordx4 v1, s[60:63], s45 offen offset:1024 sc1 lds
    buffer_load_dwordx4 v1, s[60:63], s45 offen offset:2048 sc1 lds
    buffer_load_dwordx4 v1, s[60:63], s45 offen offset:3072 sc1 lds
    s_mov_b32 m0, s44
    s_waitcnt vmcnt(0)
    ds_read2st64_b32 v[30:31], v3 offset0:0 offset1:4
    ds_read2st64_b32 v[32:33], v3 offset0:8 offset1:12
    s_waitcnt lgkmcnt(0)
    v_max3_u32 v30, v30, v31, v32
    v_max_u32 v30, v30, v33
    v_cmp_eq_u32 vcc, -1, v30
    s_cbranch_vccnz LX_h4
    s_branch LR_h4
LX_h3:
    s_mov_b32 s44, m0
    s_add_u32 m0, s85, 49152
    s_add_u32 s45, s73, 49152
    buffer_load_dwordx4 v1, s[60:63], s45 offen offset:0 sc1 lds
    buffer_load_dwordx4 v1, s[60:63], s45 offen offset:1024 sc1 lds
    buffer_load_dwordx4 v1, s[60:63], s45 offen offset:2048 sc1 lds
    buffer_load_dwordx4 v1, s[60:63], s45 offen offset:3072 sc1 lds
    s_mov_b32 m0, s44
    s_waitcnt vmcnt(0)
    ds_read2st64_b32 v[30:31], v3 offset0:192 offset1:196
    ds_read2st64_b32 v[32:33], v3 offset0:200 offset1:204
    s_waitcnt lgkmcnt(0)
    v_max3_u32 v30, v30, v31, v32
    v_max_u32 v30, v30, v33
    v_cmp_eq_u32 vcc, -1, v30
    s_cbranch_vccnz LX_h3
    s_branch LR_h3
LX_h2:
    s_mov_b32 s44, m0
    s_add_u32 m0, s85, 32768
    s_add_u32 s45, s73, 32768
    buffer_load_dwordx4 v1, s[60:63], s45 offen offset:0 sc1 lds
    buffer_load_dwordx4 v1, s[60:63], s45 offen offset:1024 sc1 lds
    buffer_load_dwordx4 v1, s[60:63], s45 offen offset:2048 sc1 lds
    buffer_load_dwordx4 v1, s[60:63], s45 offen offset:3072 sc1 lds
    s_mov_b32 m0, s44
    s_waitcnt vmcnt(0)
    ds_read2st64_b32 v[30:31], v3 offset0:128 offset1:132
    ds_read2st64_b32 v[32:33], v3 offset0:136 offset1:140
    s_waitcnt lgkmcnt(0)
    v_max3_u32 v30, v30, v31, v32
    v_max_u32 v30, v30, v33
    v_cmp_eq_u32 vcc, -1, v30
    s_cbranch_vccnz LX_h2
    s_branch LR_h2
LX_st:
    buffer_load_dwordx4 v[160:163], v1, s[60:63], s74 offen offset:0 sc1
    buffer_load_dwordx4 v[164:167], v1, s[60:63], s74 offen offset:1024 sc1
    buffer_load_dwordx4 v[168:171], v1, s[60:63], s74 offen offset:2048 sc1
    buffer_load_dwordx4 v[172:175], v1, s[60:63], s74 offen offset:3072 sc1
    s_waitcnt vmcnt(0)
    v_max3_u32 v240, v160, v161, v162
    v_max3_u32 v241, v163, v164, v165
    v_max3_u32 v240, v240, v166, v167
    v_max3_u32 v241, v241, v168, v169
    v_max3_u32 v240, v240, v170, v171
    v_max3_u32 v241, v241, v172, v173
    v_max3_u32 v240, v240, v174, v175
    v_max_u32 v240, v240, v241
    v_cmp_eq_u32 vcc, -1, v240
    s_cbranch_vccnz LX_st
    v_add_f32 v160, v160, v168
    v_add_f32 v161, v161, v169
    v_add_f32 v162, v162, v170
    v_add_f32 v163, v163, v171
    v_add_f32 v164, v164, v172
    v_add_f32 v165, v165, v173
    v_add_f32 v166, v166, v174
    v_add_f32 v167, v167, v175
    v_add_f32 v160, v160, v164
    v_add_f32 v161, v161, v165
    v_add_f32 v162, v162, v166
    v_add_f32 v163, v163, v167
    s_nop 0
    v_permlane32_swap_b32 v160, v162
    v_permlane32_swap_b32 v161, v163
    v_add_f32 v160, v160, v162
    v_add_f32 v161, v161, v163
    v_mov_b32 v162, v160
    v_mov_b32 v163, v161
    s_nop 0
    v_permlane16_swap_b32 v160, v162
    v_permlane16_swap_b32 v161, v163
    v_add_f32 v160, v160, v162
    v_add_f32 v161, v161, v163
    s_branch LR_st
LX_h1:
    s_mov_b32 s44, m0
    s_add_u32 m0, s85, 16384
    s_add_u32 s45, s73, 16384
    buffer_load_dwordx4 v1, s[60:63], s45 offen offset:0 sc1 lds
    buffer_load_dwordx4 v1, s[60:63], s45 offen offset:1024 sc1 lds
    buffer_load_dwordx4 v1, s[60:63], s45 offen offset:2048 sc1 lds
    buffer_load_dwordx4 v1, s[60:63], s45 offen offset:3072 sc1 lds
    s_mov_b32 m0, s44
    s_waitcnt vmcnt(0)
    ds_read2st64_b32 v[30:31], v3 offset0:64 offset1:68
    ds_read2st64_b32 v[32:33], v3 offset0:72 offset1:76
    s_waitcnt lgkmcnt(0)
    v_max3_u32 v30, v30, v31, v32
    v_max_u32 v30, v30, v33
    v_cmp_eq_u32 vcc, -1, v30
    s_cbranch_vccnz LX_h1
    s_branch LR_h1
LX_h0:
    s_mov_b32 s44, m0
    s_add_u32 m0, s85, 131072
    s_add_u32 s45, s73, 0
    buffer_load_dwordx4 v1, s[60:63], s45 offen offset:0 sc1 lds
    buffer_load_dwordx4 v1, s[60:63], s45 offen offset:1024 sc1 lds
    buffer_load_dwordx4 v1, s[60:63], s45 offen offset:2048 sc1 lds
    buffer_load_dwordx4 v1, s[60:63], s45 offen offset:3072 sc1 lds
    s_mov_b32 m0, s44
    s_waitcnt vmcnt(0)
    ds_read2st64_b32 v[30:31], v3 offset0:0 offset1:4
    ds_read2st64_b32 v[32:33], v3 offset0:8 offset1:12
    s_waitcnt lgkmcnt(0)
    v_max3_u32 v30, v30, v31, v32
    v_max_u32 v30, v30, v33
    v_cmp_eq_u32 vcc, -1, v30
    s_cbranch_vccnz LX_h0
    s_branch LR_h0
LC_idle:
    s_add_u32 m0, s85, 16384
    s_add_u32 s83, s73, 16384
    s_and_b32 s44, s69, 3
    s_lshl_b32 s44, s44, 13
    s_mul_i32 s45, s3, 458752
    s_add_u32 s44, s44, s45
    v_lshlrev_b32 v234, 7, v0
    s_add_u32 s45, s44, 229376
    buffer_load_dword v235, v234, s[52:55], s45 offen
    s_add_u32 s45, s44, 262144
    buffer_load_dword v235, v234, s[52:55], s45 offen
    s_add_u32 s45, s44, 294912
    buffer_load_dword v235, v234, s[52:55], s45 offen
    s_add_u32 s45, s44, 327680
    buffer_load_dword v235, v234, s[52:55], s45 offen
    s_waitcnt vmcnt(4) lgkmcnt(0)
    s_barrier
    s_add_u32 m0, s85, 0
    s_add_u32 s83, s47, 0
    buffer_load_dwordx4 v35, s[52:55], s83 offen offset:0 lds
    buffer_load_dwordx4 v36, s[52:55], s83 offen offset:1024 lds
    buffer_load_dwordx4 v37, s[52:55], s83 offen offset:2048 lds
    buffer_load_dwordx4 v38, s[52:55], s83 offen offset:3072 lds
    s_add_u32 m0, s85, 131072
    s_add_u32 s83, s47, 32768
    buffer_load_dwordx4 v35, s[52:55], s83 offen offset:0 lds
    buffer_load_dwordx4 v36, s[52:55], s83 offen offset:1024 lds
    buffer_load_dwordx4 v37, s[52:55], s83 offen offset:2048 lds
    buffer_load_dwordx4 v38, s[52:55], s83 offen offset:3072 lds
    s_add_u32 m0, s85, 16384
    s_add_u32 s83, s47, 65536
    buffer_load_dwordx4 v35, s[52:55], s83 offen offset:0 lds
    buffer_load_dwordx4 v36, s[52:55], s83 offen offset:1024 lds
    buffer_load_dwordx4 v37, s[52:55], s83 offen offset:2048 lds
    buffer_load_dwordx4 v38, s[52:55], s83 offen offset:3072 lds
    s_add_u32 m0, s85, 32768
    s_add_u32 s83, s47, 98304
    buffer_load_dwordx4 v35, s[52:55], s83 offen offset:0 lds
    buffer_load_dwordx4 v36, s[52:55], s83 offen offset:1024 lds
    buffer_load_dwordx4 v37, s[52:55], s83 offen offset:2048 lds
    buffer_load_dwordx4 v38, s[52:55], s83 offen offset:3072 lds
    s_add_u32 m0, s85, 49152
    s_add_u32 s83, s47, 131072
    buffer_load_dwordx4 v35, s[52:55], s83 offen offset:0 lds
    buffer_load_dwordx4 v36, s[52:55], s83 offen offset:1024 lds
    buffer_load_dwordx4 v37, s[52:55], s83 offen offset:2048 lds
    buffer_load_dwordx4 v38, s[52:55], s83 offen offset:3072 lds
    s_add_u32 m0, s85, 65536
    s_add_u32 s83, s47, 163840
    buffer_load_dwordx4 v35, s[52:55], s83 offen offset:0 lds
    buffer_load_dwordx4 v36, s[52:55], s83 offen offset:1024 lds
    buffer_load_dwordx4 v37, s[52:55], s83 offen offset:2048 lds
    buffer_load_dwordx4 v38, s[52:55], s83 offen offset:3072 lds
    s_add_u32 m0, s85, 81920
    s_add_u32 s83, s47, 327680
    buffer_load_dwordx4 v35, s[52:55], s83 offen offset:0 lds
    buffer_load_dwordx4 v36, s[52:55], s83 offen offset:1024 lds
    buffer_load_dwordx4 v37, s[52:55], s83 offen offset:2048 lds
    buffer_load_dwordx4 v38, s[52:55], s83 offen offset:3072 lds
    s_add_u32 m0, s85, 98304
    s_add_u32 s83, s47, 393216
    buffer_load_dwordx4 v35, s[52:55], s83 offen offset:0 lds
    buffer_load_dwordx4 v36, s[52:55], s83 offen offset:1024 lds
    buffer_load_dwordx4 v37, s[52:55], s83 offen offset:2048 lds
    buffer_load_dwordx4 v38, s[52:55], s83 offen offset:3072 lds
    s_waitcnt vmcnt(28)
    ds_read_b64_tr_b16 v[164:165], v7 offset:0
    ds_read_b64_tr_b16 v[166:167], v7 offset:2048
    ds_read_b64_tr_b16 v[168:169], v10 offset:0
    ds_read_b64_tr_b16 v[170:171], v10 offset:2048
    ds_read_b64_tr_b16 v[172:173], v13 offset:0
    ds_read_b64_tr_b16 v[174:175], v13 offset:2048
    ds_read_b64_tr_b16 v[160:161], v4 offset:0
    ds_read_b64_tr_b16 v[162:163], v4 offset:2048
    s_waitcnt lgkmcnt(0)
    s_add_u32 m0, s85, 0
    s_add_u32 s83, s47, 294912
    buffer_load_dwordx4 v35, s[52:55], s83 offen offset:0 lds
    buffer_load_dwordx4 v36, s[52:55], s83 offen offset:1024 lds
    buffer_load_dwordx4 v37, s[52:55], s83 offen offset:2048 lds
    buffer_load_dwordx4 v38, s[52:55], s83 offen offset:3072 lds
    s_waitcnt vmcnt(28)
    ds_read_b64_tr_b16 v[180:181], v9 offset:0
    ds_read_b64_tr_b16 v[182:183], v9 offset:2048
    ds_read_b64_tr_b16 v[184:185], v12 offset:0
    ds_read_b64_tr_b16 v[186:187], v12 offset:2048
    ds_read_b64_tr_b16 v[188:189], v15 offset:0
    ds_read_b64_tr_b16 v[190:191], v15 offset:2048
    ds_read_b64_tr_b16 v[176:177], v6 offset:0
    ds_read_b64_tr_b16 v[178:179], v6 offset:2048
    s_waitcnt lgkmcnt(0)
    s_add_u32 m0, s85, 131072
    s_add_u32 s83, s47, 425984
    buffer_load_dwordx4 v35, s[52:55], s83 offen offset:0 lds
    buffer_load_dwordx4 v36, s[52:55], s83 offen offset:1024 lds
    buffer_load_dwordx4 v37, s[52:55], s83 offen offset:2048 lds
    buffer_load_dwordx4 v38, s[52:55], s83 offen offset:3072 lds
    s_waitcnt vmcnt(28)
    ds_read_b64_tr_b16 v[196:197], v7 offset:16384
    ds_read_b64_tr_b16 v[198:199], v7 offset:18432
    ds_read_b64_tr_b16 v[200:201], v10 offset:16384
    ds_read_b64_tr_b16 v[202:203], v10 offset:18432
    ds_read_b64_tr_b16 v[204:205], v13 offset:16384
    ds_read_b64_tr_b16 v[206:207], v13 offset:18432
    ds_read_b64_tr_b16 v[192:193], v4 offset:16384
    ds_read_b64_tr_b16 v[194:195], v4 offset:18432
    s_waitcnt lgkmcnt(0)
    s_add_u32 m0, s85, 16384
    s_add_u32 s83, s47, 229376
    buffer_load_dwordx4 v35, s[52:55], s83 offen offset:0 lds
    buffer_load_dwordx4 v36, s[52:55], s83 offen offset:1024 lds
    buffer_load_dwordx4 v37, s[52:55], s83 offen offset:2048 lds
    buffer_load_dwordx4 v38, s[52:55], s83 offen offset:3072 lds
    s_waitcnt vmcnt(28)
    ds_read_b64_tr_b16 v[212:213], v7 offset:32768
    ds_read_b64_tr_b16 v[214:215], v7 offset:34816
    ds_read_b64_tr_b16 v[216:217], v10 offset:32768
    ds_read_b64_tr_b16 v[218:219], v10 offset:34816
    ds_read_b64_tr_b16 v[220:221], v13 offset:32768
    ds_read_b64_tr_b16 v[222:223], v13 offset:34816
    ds_read_b64_tr_b16 v[208:209], v4 offset:32768
    ds_read_b64_tr_b16 v[210:211], v4 offset:34816
    s_waitcnt lgkmcnt(0)
    s_add_u32 m0, s85, 32768
    s_add_u32 s83, s47, 360448
    buffer_load_dwordx4 v35, s[52:55], s83 offen offset:0 lds
    buffer_load_dwordx4 v36, s[52:55], s83 offen offset:1024 lds
    buffer_load_dwordx4 v37, s[52:55], s83 offen offset:2048 lds
    buffer_load_dwordx4 v38, s[52:55], s83 offen offset:3072 lds
    s_waitcnt vmcnt(28)
    ds_read_b64_tr_b16 v[228:229], v7 offset:49152
    ds_read_b64_tr_b16 v[230:231], v7 offset:51200
    ds_read_b64_tr_b16 v[232:233], v10 offset:49152
    ds_read_b64_tr_b16 v[234:235], v10 offset:51200
    ds_read_b64_tr_b16 v[236:237], v13 offset:49152
    ds_read_b64_tr_b16 v[238:239], v13 offset:51200
    ds_read_b64_tr_b16 v[224:225], v4 offset:49152
    ds_read_b64_tr_b16 v[226:227], v4 offset:51200
    s_waitcnt lgkmcnt(0)
    s_add_u32 m0, s85, 49152
    s_add_u32 s83, s47, 196608
    buffer_load_dwordx4 v35, s[52:55], s83 offen offset:0 lds
    buffer_load_dwordx4 v36, s[52:55], s83 offen offset:1024 lds
    buffer_load_dwordx4 v37, s[52:55], s83 offen offset:2048 lds
    buffer_load_dwordx4 v38, s[52:55], s83 offen offset:3072 lds
    s_waitcnt vmcnt(28)
    ds_read_b64_tr_b16 v[244:245], v8 offset:0
    ds_read_b64_tr_b16 v[246:247], v8 offset:2048
    ds_read_b64_tr_b16 v[248:249], v11 offset:0
    ds_read_b64_tr_b16 v[250:251], v11 offset:2048
    ds_read_b64_tr_b16 v[252:253], v14 offset:0
    ds_read_b64_tr_b16 v[254:255], v14 offset:2048
    ds_read_b64_tr_b16 v[240:241], v5 offset:0
    ds_read_b64_tr_b16 v[242:243], v5 offset:2048
    s_waitcnt lgkmcnt(0)
    s_add_u32 m0, s85, 65536
    s_add_u32 s83, s47, 262144
    buffer_load_dwordx4 v35, s[52:55], s83 offen offset:0 lds
    buffer_load_dwordx4 v36, s[52:55], s83 offen offset:1024 lds
    buffer_load_dwordx4 v37, s[52:55], s83 offen offset:2048 lds
    buffer_load_dwordx4 v38, s[52:55], s83 offen offset:3072 lds
    v_min_u32 v100, 13, v0
    v_lshlrev_b32 v100, 10, v100
    s_add_u32 s45, s79, 256
    s_add_u32 s46, s82, 229376
    s_bitcmp1_b32 s69, 1
    s_cselect_b32 s44, 57344, 0
    s_sub_u32 s46, s46, s44
LI_hr:
    s_add_u32 s83, s86, 0
    buffer_load_dwordx2 v[16:17], v25, s[60:63], s83 offen sc1
    s_add_u32 s83, s86, 32768
    buffer_load_dwordx2 v[18:19], v25, s[60:63], s83 offen sc1
    s_add_u32 s83, s86, 65536
    buffer_load_dwordx2 v[26:27], v25, s[60:63], s83 offen sc1
    buffer_load_dwordx2 v[28:29], v1, s[60:63], s66 offen sc1
LI_poll:
    buffer_load_dword v101, v100, s[60:63], s46 offen sc1
    s_waitcnt vmcnt(0)
    v_max3_u32 v34, v16, v18, v26
    v_max_u32 v34, v34, v28
    v_cmp_eq_u32 vcc, -1, v34
    s_cbranch_vccnz LI_hr
    v_cmp_eq_u32 vcc, -1, v101
    s_cbranch_vccnz LI_poll
LI_pb:
    buffer_load_dword v24, v23, s[60:63], s45 offen sc1
    s_waitcnt vmcnt(0)
    v_cmp_gt_u32 vcc, 1, v24
    s_cbranch_vccnz LI_pb
    s_add_u32 s70, s82, 0
    buffer_load_dwordx4 a[0:3], v1, s[60:63], s70 offen offset:0 sc1
    buffer_load_dwordx4 a[4:7], v1, s[60:63], s70 offen offset:1024 sc1
    buffer_load_dwordx4 a[8:11], v1, s[60:63], s70 offen offset:2048 sc1
    buffer_load_dwordx4 a[12:15], v1, s[60:63], s70 offen offset:3072 sc1
    s_add_u32 s70, s82, 4096
    buffer_load_dwordx4 a[16:19], v1, s[60:63], s70 offen offset:0 sc1
    buffer_load_dwordx4 a[20:23], v1, s[60:63], s70 offen offset:1024 sc1
    buffer_load_dwordx4 a[24:27], v1, s[60:63], s70 offen offset:2048 sc1
    buffer_load_dwordx4 a[28:31], v1, s[60:63], s70 offen offset:3072 sc1
    s_add_u32 s70, s82, 8192
    buffer_load_dwordx4 a[128:131], v1, s[60:63], s70 offen offset:0 sc1
    s_add_u32 s70, s82, 114688
    buffer_load_dwordx4 a[32:35], v1, s[60:63], s70 offen offset:0 sc1
    buffer_load_dwordx4 a[36:39], v1, s[60:63], s70 offen offset:1024 sc1
    buffer_load_dword v24, v23, s[60:63], s45 offen
    buffer_load_dwordx4 a[40:43], v1, s[60:63], s70 offen offset:2048 sc1
    buffer_load_dwordx4 a[44:47], v1, s[60:63], s70 offen offset:3072 sc1
    s_add_u32 s70, s82, 118784
    buffer_load_dwordx4 a[48:51], v1, s[60:63], s70 offen offset:0 sc1
    buffer_load_dwordx4 a[52:55], v1, s[60:63], s70 offen offset:1024 sc1
    s_waitcnt lgkmcnt(0)
    s_branch LD_start
LX_early:
    s_barrier
    ds_read_b64_tr_b16 a[136:137], v6 offset:0
    ds_read_b64_tr_b16 a[138:139], v6 offset:1024
    ds_read_b64_tr_b16 a[200:201], v12 offset:0
    ds_read_b64_tr_b16 a[202:203], v12 offset:1024
    ds_read_b64_tr_b16 a[140:141], v5 offset:0
    ds_read_b64_tr_b16 a[142:143], v5 offset:1024
    ds_read_b64_tr_b16 a[204:205], v11 offset:0
    ds_read_b64_tr_b16 a[206:207], v11 offset:1024
    ds_read_b64_tr_b16 a[152:153], v7 offset:0
    ds_read_b64_tr_b16 a[154:155], v7 offset:1024
    ds_read_b64_tr_b16 a[216:217], v13 offset:0
    ds_read_b64_tr_b16 a[218:219], v13 offset:1024
    ds_read_b64_tr_b16 a[156:157], v5 offset:16384
    ds_read_b64_tr_b16 a[158:159], v5 offset:17408
    ds_read_b64_tr_b16 a[220:221], v11 offset:16384
    ds_read_b64_tr_b16 a[222:223], v11 offset:17408
    ds_read_b64_tr_b16 a[168:169], v8 offset:0
    ds_read_b64_tr_b16 a[170:171], v8 offset:1024
    ds_read_b64_tr_b16 a[232:233], v14 offset:0
    ds_read_b64_tr_b16 a[234:235], v14 offset:1024
    ds_read_b64_tr_b16 a[172:173], v5 offset:32768
    ds_read_b64_tr_b16 a[174:175], v5 offset:33792
    ds_read_b64_tr_b16 a[236:237], v11 offset:32768
    ds_read_b64_tr_b16 a[238:239], v11 offset:33792
    ds_read_b64_tr_b16 a[184:185], v9 offset:0
    ds_read_b64_tr_b16 a[186:187], v9 offset:1024
    ds_read_b64_tr_b16 a[248:249], v15 offset:0
    ds_read_b64_tr_b16 a[250:251], v15 offset:1024
    ds_read_b64_tr_b16 a[188:189], v5 offset:49152
    ds_read_b64_tr_b16 a[190:191], v5 offset:50176
    ds_read_b64_tr_b16 a[252:253], v11 offset:49152
    ds_read_b64_tr_b16 a[254:255], v11 offset:50176
LB_poll:
    buffer_load_dword v136, v31, s[60:63], s82 offen sc1
    s_waitcnt vmcnt(0)
    v_cmp_gt_u32 vcc, 1, v136
    s_cbranch_vccnz LB_poll
    buffer_load_dwordx4 v[228:231], v30, s[60:63], s72 offen offset:2048 sc1
    buffer_load_dwordx4 v[44:47], v1, s[60:63], s72 offen offset:0 sc1
    buffer_load_dwordx4 v[104:107], v1, s[60:63], s81 offen offset:0 sc1
    buffer_load_dwordx4 v[52:55], v1, s[60:63], s72 offen offset:1024 sc1
    buffer_load_dwordx4 v[108:111], v1, s[60:63], s81 offen offset:1024 sc1
    buffer_load_dwordx4 v[60:63], v1, s[60:63], s72 offen offset:2176 sc1
    buffer_load_dwordx4 v[112:115], v1, s[60:63], s81 offen offset:2048 sc1
    buffer_load_dwordx4 v[68:71], v1, s[60:63], s72 offen offset:3200 sc1
    buffer_load_dwordx4 v[116:119], v1, s[60:63], s81 offen offset:3072 sc1
    buffer_load_dwordx4 v[76:79], v1, s[60:63], s73 offen offset:0 sc1
    buffer_load_dwordx4 v[120:123], v1, s[60:63], s75 offen offset:0 sc1
    buffer_load_dwordx4 v[84:87], v1, s[60:63], s73 offen offset:1024 sc1
    buffer_load_dwordx4 v[124:127], v1, s[60:63], s75 offen offset:1024 sc1
    buffer_load_dwordx4 v[92:95], v1, s[60:63], s73 offen offset:2176 sc1
    buffer_load_dwordx4 v[128:131], v1, s[60:63], s75 offen offset:2048 sc1
    buffer_load_dwordx4 v[100:103], v1, s[60:63], s73 offen offset:3200 sc1
    buffer_load_dwordx4 v[132:135], v1, s[60:63], s75 offen offset:3072 sc1
    s_branch LB_join
LX_dbg:
    buffer_load_dword v216, v217, s[64:67], 0 offen sc1
    s_waitcnt vmcnt(0)
    s_branch LA_chk
Lfin:
.section .rodata,"a"
.p2align 6
.amdhsa_kernel sequential_preLN__linear_attn_block__geglu_ffn__prompt_kernel
  .amdhsa_next_free_vgpr 512
  .amdhsa_next_free_sgpr 102
  .amdhsa_accum_offset 256
  .amdhsa_group_segment_fixed_size 0
  .amdhsa_kernarg_size 80
  .amdhsa_user_sgpr_count 2
  .amdhsa_user_sgpr_kernarg_segment_ptr 1
  .amdhsa_system_sgpr_workgroup_id_x 1
.end_amdhsa_kernel
```
